```python
import torch

def _softmax(x, axis=-1):
    return torch.softmax(x, dim=axis)
def _gelu(x):
    return torch.nn.functional.gelu(x, approximate="tanh")
def _silu(x):
    return torch.nn.functional.silu(x)
def _sigmoid(x):
    return torch.sigmoid(x)
def _layernorm(x, axis=-1, eps=1e-5):
    m = x.mean(dim=axis, keepdim=True)
    v = x.var(dim=axis, keepdim=True, unbiased=False)
    return (x - m) / torch.sqrt(v + eps)
def _scatter_add(tgt, idx, src, axis=0):
    return tgt.clone().index_add_(axis, idx, src)
def _segment_sum(src, seg, n):
    out = torch.zeros((n,) + src.shape[1:], dtype=src.dtype)
    return out.index_add_(0, seg, src)
def _pad(x, pw):
    flat = tuple(v for pair in reversed(pw) for v in pair)
    return torch.nn.functional.pad(x, flat)

kernel_name = 'recurrent_scan__grouped_kv_mqa__glu_gated_reglu__prompt'

def setup_inputs():

    _w = (lambda a: (lambda t: t.to(torch.bfloat16) if t.is_floating_point() else t)(torch.as_tensor(a)))
    def _A_setup():
        B, S, D, H = 1, 2048, 512, 32
        Dh = D // H
        return {
            "x": _w((lambda *s: torch.randn(*s, dtype=torch.bfloat16) * 0.05)(B, S, D)),
            "wq": _w((lambda *s: torch.randn(*s, dtype=torch.bfloat16) * 0.2)(D, H * Dh)),
            "wk": _w((lambda *s: torch.randn(*s, dtype=torch.bfloat16) * 0.2)(D, Dh)),
            "wv": _w((lambda *s: torch.randn(*s, dtype=torch.bfloat16) * 0.2)(D, Dh)),
            "wo": _w((lambda *s: torch.randn(*s, dtype=torch.bfloat16) * 0.2)(H * Dh, D)),
        }
    _A_in = _A_setup()

    def _B_setup():
        B, S, D, F = 1, 2048, 512, 1792
        return {
            "x": _w((lambda *s: torch.randn(*s, dtype=torch.bfloat16) * 0.05)(B, S, D)),
            "W_gate": _w((lambda *s: torch.randn(*s, dtype=torch.bfloat16) * 0.1)(D, F) * (2.0 / D) ** 0.5),
            "W_up": _w((lambda *s: torch.randn(*s, dtype=torch.bfloat16) * 0.1)(D, F) * (2.0 / D) ** 0.5),
            "W_down": _w((lambda *s: torch.randn(*s, dtype=torch.bfloat16) * 0.1)(F, D) * (1.0 / F) ** 0.5),
        }
    _B_in = _B_setup()

    return {
        "A_x": _A_in["x"],
        "A_wq": _A_in["wq"],
        "A_wk": _A_in["wk"],
        "A_wv": _A_in["wv"],
        "A_wo": _A_in["wo"],
        "B_x": _B_in["x"],
        "B_W_gate": _B_in["W_gate"],
        "B_W_up": _B_in["W_up"],
        "B_W_down": _B_in["W_down"],
    }

def reference(A_x, A_wq, A_wk, A_wv, A_wo, B_x, B_W_gate, B_W_up, B_W_down):
    def _A_ref(x, wq, wk, wv, wo):
        B, S, D = x.shape
        H = 32
        Dh = D // H
        q = (lambda x, *d: x.permute(*d))((x @ wq).reshape(B, S, H, Dh), 0, 2, 1, 3)
        k = x @ wk
        v = x @ wv
        scores = torch.einsum("bhqd,bkd->bhqk", q, k) * (Dh ** -0.5)
        p = _softmax(scores, axis=-1)
        o = torch.einsum("bhqk,bkd->bhqd", p, v)
        return (lambda x, *d: x.permute(*d))(o, 0, 2, 1, 3).reshape(B, S, H * Dh) @ wo

    def _B_ref(x, W_gate, W_up, W_down):
        gate = torch.einsum("bsd,df->bsf", x, W_gate)
        up = torch.einsum("bsd,df->bsf", x, W_up)
        gate = gate * (lambda x, dt: x.to(dt))(gate > 0, gate.dtype)
        h = gate * up
        return torch.einsum("bsf,fd->bsd", h, W_down)

    x = A_x
    xn = _layernorm(x, axis=-1)
    s = _A_ref(xn, A_wq, A_wk, A_wv, A_wo)
    g = _silu(_B_ref(xn, B_W_gate, B_W_up, B_W_down))
    return x + s * g
```

```asm
; @launch grid=(256,1,1) block=(512,1,1) lds=163840
.amdgcn_target "amdgcn-amd-amdhsa--gfx950"
.text
.globl recurrent_scan__grouped_kv_mqa__glu_gated_reglu__prompt_kernel
.p2align 8
.type recurrent_scan__grouped_kv_mqa__glu_gated_reglu__prompt_kernel,@function
recurrent_scan__grouped_kv_mqa__glu_gated_reglu__prompt_kernel:
    s_cmp_ge_u32 s2, 256
    s_cbranch_scc1 kf_end
    s_load_dwordx8 s[4:11], s[0:1], 0
    s_load_dwordx4 s[12:15], s[0:1], 80
    s_load_dwordx8 s[64:71], s[0:1], 48
    s_load_dwordx2 s[72:73], s[0:1], 32
    v_lshrrev_b32 v1, 6, v0
    v_and_b32 v2, 63, v0
    v_readfirstlane_b32 s32, v1
    s_and_b32 s39, s2, 1
    s_lshl_b32 s39, s39, 2
    s_bfe_u32 s35, s2, 0x20003
    s_add_u32 s39, s39, s35
    s_bfe_u32 s38, s2, 0x20001
    s_lshl_b32 s38, s38, 3
    s_lshr_b32 s35, s2, 5
    s_add_u32 s38, s38, s35
    v_lshrrev_b32 v3, 4, v2
    v_and_b32 v4, 15, v2
    v_lshlrev_b32 v5, 10, v3
    v_lshl_add_u32 v6, v4, 4, v5
    v_lshlrev_b32 v56, 4, v2
    s_and_b32 s37, s39, 3
    s_lshl_b32 s37, s37, 2
    s_add_u32 s37, s37, s32
    s_and_b32 s37, s37, 15
    s_lshl_b32 s36, s38, 16
    s_lshl_b32 s40, s37, 12
    s_add_u32 s36, s36, s40
    s_xor_b32 s54, s36, 0x8000
    s_getpc_b64 s[76:77]
kf_pc:
    s_lshr_b32 s40, s2, 3
    s_and_b32 s40, s40, 15
    s_mul_i32 s40, s40, 28*128
    v_min_u32 v7, 28-1, v2
    v_lshlrev_b32 v7, 7, v7
    v_add_u32 v7, s40, v7
    v_min_u32 v7, kf_end-kf_pc, v7
    s_waitcnt lgkmcnt(0)
    s_mov_b32 s16, s4
    s_and_b32 s17, s5, 0xffff
    s_mov_b32 s18, 2097152
    s_mov_b32 s19, 0x20000
    s_cmp_ge_u32 s32, 4
    s_cbranch_scc1 1f
    buffer_load_dwordx4 v[8:11], v6, s[16:19], s36 offen offset:0
    buffer_load_dwordx4 v[12:15], v6, s[16:19], s36 offen offset:256
    buffer_load_dwordx4 v[16:19], v6, s[16:19], s36 offen offset:512
    buffer_load_dwordx4 v[20:23], v6, s[16:19], s36 offen offset:768
    s_cmp_ge_u32 s39, 4
    s_cselect_b32 s24, s10, s8
    s_cselect_b32 s25, s11, s9
    s_and_b32 s25, s25, 0xffff
    s_mov_b32 s26, 16384
    s_mov_b32 s27, 0x20000
    s_lshl_b32 s42, s32, 12
    s_add_u32 m0, s42, 102400
    s_nop 0
    buffer_load_dwordx4 v56, s[24:27], s42 offen lds
    buffer_load_dwordx4 v56, s[24:27], s42 offen offset:1024 lds
    buffer_load_dwordx4 v56, s[24:27], s42 offen offset:2048 lds
    buffer_load_dwordx4 v56, s[24:27], s42 offen offset:3072 lds
1:
    s_cmp_eq_u32 s32, 7
    s_cbranch_scc0 1f
    global_load_dword v127, v7, s[76:77]
1:
    s_or_b32 s40, s2, s32
    s_cmp_eq_u32 s40, 0
    s_cbranch_scc0 1f
    s_memrealtime s[40:41]
    s_mov_b32 s24, s12
    s_and_b32 s25, s13, 0xffff
    s_mov_b32 s26, 256
    s_mov_b32 s27, 0x20000
    s_waitcnt lgkmcnt(0)
    s_or_b32 s40, s40, 1
    v_mov_b32 v40, s40
    v_mov_b32 v41, s41
    v_mov_b32 v42, 0
    s_mov_b64 exec, 1
    buffer_store_dwordx2 v[40:41], v42, s[24:27], 0 offen sc1
    s_mov_b64 exec, -1
1:
    v_mov_b32 v40, -1
    v_mov_b32 v41, -1
    v_mov_b32 v42, -1
    v_mov_b32 v43, -1
    s_lshl_b32 s41, s32, 11
    s_add_u32 s41, s41, 82944
    v_add_u32 v44, s41, v56
    ds_write_b128 v44, v[40:43]
    v_mov_b32 v40, 0
    v_lshlrev_b32 v44, 2, v2
    v_add_u32 v44, 100352, v44
    ds_write_b32 v44, v40
    s_and_b32 s35, s32, 3
    s_mov_b32 s20, s6
    s_and_b32 s21, s7, 0xffff
    s_mov_b32 s22, 524288
    s_mov_b32 s23, 0x20000
    s_and_b32 s41, s38, 7
    s_lshl_b32 s41, s41, 2
    s_add_u32 s41, s41, s35
    s_mul_i32 s41, s41, 16384
    s_lshl_b32 s43, s39, 7
    s_add_u32 s41, s41, s43
    v_min_u32 v7, 15, v2
    v_lshlrev_b32 v7, 10, v7
    s_waitcnt lgkmcnt(0)
    s_barrier
    s_cmp_lt_u32 s32, 4
    s_cbranch_scc1 1f
    buffer_load_dword v126, v7, s[20:23], s41 offen
    buffer_load_dwordx4 v[8:11], v6, s[16:19], s36 offen offset:0
    buffer_load_dwordx4 v[12:15], v6, s[16:19], s36 offen offset:256
    buffer_load_dwordx4 v[16:19], v6, s[16:19], s36 offen offset:512
    buffer_load_dwordx4 v[20:23], v6, s[16:19], s36 offen offset:768
    buffer_load_dwordx4 v[24:27], v6, s[16:19], s54 offen offset:0
    buffer_load_dwordx4 v[28:31], v6, s[16:19], s54 offen offset:256
    buffer_load_dwordx4 v[32:35], v6, s[16:19], s54 offen offset:512
    buffer_load_dwordx4 v[36:39], v6, s[16:19], s54 offen offset:768
1:
    s_mov_b32 s28, s14
    s_and_b32 s29, s15, 0xffff
    s_mov_b32 s30, 18874368
    s_mov_b32 s31, 0x20000
    v_mov_b32 v44, 0x3f803f80
    v_and_b32 v45, 1, v2
    v_lshlrev_b32 v45, 5, v45
    s_and_b32 s40, s37, 7
    s_lshl_b32 s40, s40, 2
    v_add3_u32 v45, v45, v3, s40
    v_and_b32 v46, 7, v2
    v_xor_b32 v45, v45, v46
    v_lshlrev_b32 v45, 4, v45
    v_lshrrev_b32 v46, 1, v4
    v_lshl_add_u32 v45, v46, 10, v45
    s_lshr_b32 s40, s37, 3
    s_lshl_b32 s40, s40, 15
    v_add_u32 v45, s40, v45
    v_xor_b32 v7, 0x8000, v45
    v_lshrrev_b32 v46, 5, v2
    v_add_u32 v47, 0, v46
    v_xor_b32 v47, v47, v2
    v_lshlrev_b32 v47, 4, v47
    v_add_u32 v52, 0, v47
    v_add_u32 v47, 2, v46
    v_xor_b32 v47, v47, v2
    v_lshlrev_b32 v47, 4, v47
    v_add_u32 v53, 1024, v47
    v_add_u32 v47, 4, v46
    v_xor_b32 v47, v47, v2
    v_lshlrev_b32 v47, 4, v47
    v_add_u32 v54, 2048, v47
    v_add_u32 v47, 6, v46
    v_xor_b32 v47, v47, v2
    v_lshlrev_b32 v47, 4, v47
    v_add_u32 v55, 3072, v47
    v_bfe_u32 v47, v2, 2, 2
    v_and_b32 v48, 3, v2
    v_bfe_u32 v49, v2, 4, 1
    v_lshl_add_u32 v50, v46, 3, v47
    s_cmp_ge_u32 s32, 4
    s_cbranch_scc1 kf_ffn
    v_mov_b32 v104, 100396
    v_mov_b32 v105, 1
    v_mov_b32 v40, 0
    v_mov_b32 v41, 0
    v_mov_b32 v42, 0
    v_mov_b32 v43, 0
    s_waitcnt vmcnt(7)
    v_dot2c_f32_bf16 v40, v8, v44
    v_dot2c_f32_bf16 v42, v8, v8
    v_dot2c_f32_bf16 v41, v9, v44
    v_dot2c_f32_bf16 v43, v9, v9
    v_dot2c_f32_bf16 v40, v10, v44
    v_dot2c_f32_bf16 v42, v10, v10
    v_dot2c_f32_bf16 v41, v11, v44
    v_dot2c_f32_bf16 v43, v11, v11
    s_waitcnt vmcnt(6)
    v_dot2c_f32_bf16 v40, v12, v44
    v_dot2c_f32_bf16 v42, v12, v12
    v_dot2c_f32_bf16 v41, v13, v44
    v_dot2c_f32_bf16 v43, v13, v13
    v_dot2c_f32_bf16 v40, v14, v44
    v_dot2c_f32_bf16 v42, v14, v14
    v_dot2c_f32_bf16 v41, v15, v44
    v_dot2c_f32_bf16 v43, v15, v15
    s_waitcnt vmcnt(5)
    v_dot2c_f32_bf16 v40, v16, v44
    v_dot2c_f32_bf16 v42, v16, v16
    v_dot2c_f32_bf16 v41, v17, v44
    v_dot2c_f32_bf16 v43, v17, v17
    v_dot2c_f32_bf16 v40, v18, v44
    v_dot2c_f32_bf16 v42, v18, v18
    v_dot2c_f32_bf16 v41, v19, v44
    v_dot2c_f32_bf16 v43, v19, v19
    s_waitcnt vmcnt(4)
    v_dot2c_f32_bf16 v40, v20, v44
    v_dot2c_f32_bf16 v42, v20, v20
    v_dot2c_f32_bf16 v41, v21, v44
    v_dot2c_f32_bf16 v43, v21, v21
    v_dot2c_f32_bf16 v40, v22, v44
    v_dot2c_f32_bf16 v42, v22, v22
    v_dot2c_f32_bf16 v41, v23, v44
    v_dot2c_f32_bf16 v43, v23, v23
    buffer_load_dwordx4 v[24:27], v6, s[16:19], s54 offen offset:0
    buffer_load_dwordx4 v[28:31], v6, s[16:19], s54 offen offset:256
    buffer_load_dwordx4 v[32:35], v6, s[16:19], s54 offen offset:512
    buffer_load_dwordx4 v[36:39], v6, s[16:19], s54 offen offset:768
    v_add_f32 v40, v40, v41
    v_add_f32 v42, v42, v43
    s_nop 1
    v_add_f32_dpp v40, v40, v40 quad_perm:[1,0,3,2] row_mask:0xf bank_mask:0xf
    v_add_f32_dpp v42, v42, v42 quad_perm:[1,0,3,2] row_mask:0xf bank_mask:0xf
    s_nop 0
    v_add_f32_dpp v40, v40, v40 quad_perm:[2,3,0,1] row_mask:0xf bank_mask:0xf
    v_add_f32_dpp v42, v42, v42 quad_perm:[2,3,0,1] row_mask:0xf bank_mask:0xf
    s_nop 0
    v_add_f32_dpp v40, v40, v40 row_half_mirror row_mask:0xf bank_mask:0xf
    v_add_f32_dpp v42, v42, v42 row_half_mirror row_mask:0xf bank_mask:0xf
    s_nop 0
    v_add_f32_dpp v40, v40, v40 row_mirror row_mask:0xf bank_mask:0xf
    v_add_f32_dpp v42, v42, v42 row_mirror row_mask:0xf bank_mask:0xf
    v_mul_f32 v40, 0x3b000000, v40
    v_mul_f32 v42, 0x3b000000, v42
    v_fma_f32 v42, -v40, v40, v42
    v_max_f32 v42, 0, v42
    v_add_f32 v42, 0x3727c5ac, v42
    v_rsq_f32 v42, v42
    s_nop 0
    v_mul_f32 v40, v40, v42
    v_sub_f32 v40, 0, v40
    v_lshlrev_b32 v58, 16, v8
    v_and_b32 v59, 0xffff0000, v8
    v_fma_f32 v58, v58, v42, v40
    v_fma_f32 v59, v59, v42, v40
    v_cvt_pk_bf16_f32 v8, v58, v59
    v_lshlrev_b32 v60, 16, v9
    v_and_b32 v61, 0xffff0000, v9
    v_fma_f32 v60, v60, v42, v40
    v_fma_f32 v61, v61, v42, v40
    v_cvt_pk_bf16_f32 v9, v60, v61
    v_lshlrev_b32 v58, 16, v10
    v_and_b32 v59, 0xffff0000, v10
    v_fma_f32 v58, v58, v42, v40
    v_fma_f32 v59, v59, v42, v40
    v_cvt_pk_bf16_f32 v10, v58, v59
    v_lshlrev_b32 v60, 16, v11
    v_and_b32 v61, 0xffff0000, v11
    v_fma_f32 v60, v60, v42, v40
    v_fma_f32 v61, v61, v42, v40
    v_cvt_pk_bf16_f32 v11, v60, v61
    ds_write_b128 v45, v[8:11] offset:0
    v_lshlrev_b32 v58, 16, v12
    v_and_b32 v59, 0xffff0000, v12
    v_fma_f32 v58, v58, v42, v40
    v_fma_f32 v59, v59, v42, v40
    v_cvt_pk_bf16_f32 v12, v58, v59
    v_lshlrev_b32 v60, 16, v13
    v_and_b32 v61, 0xffff0000, v13
    v_fma_f32 v60, v60, v42, v40
    v_fma_f32 v61, v61, v42, v40
    v_cvt_pk_bf16_f32 v13, v60, v61
    v_lshlrev_b32 v58, 16, v14
    v_and_b32 v59, 0xffff0000, v14
    v_fma_f32 v58, v58, v42, v40
    v_fma_f32 v59, v59, v42, v40
    v_cvt_pk_bf16_f32 v14, v58, v59
    v_lshlrev_b32 v60, 16, v15
    v_and_b32 v61, 0xffff0000, v15
    v_fma_f32 v60, v60, v42, v40
    v_fma_f32 v61, v61, v42, v40
    v_cvt_pk_bf16_f32 v15, v60, v61
    ds_write_b128 v45, v[12:15] offset:8192
    v_lshlrev_b32 v58, 16, v16
    v_and_b32 v59, 0xffff0000, v16
    v_fma_f32 v58, v58, v42, v40
    v_fma_f32 v59, v59, v42, v40
    v_cvt_pk_bf16_f32 v16, v58, v59
    v_lshlrev_b32 v60, 16, v17
    v_and_b32 v61, 0xffff0000, v17
    v_fma_f32 v60, v60, v42, v40
    v_fma_f32 v61, v61, v42, v40
    v_cvt_pk_bf16_f32 v17, v60, v61
    v_lshlrev_b32 v58, 16, v18
    v_and_b32 v59, 0xffff0000, v18
    v_fma_f32 v58, v58, v42, v40
    v_fma_f32 v59, v59, v42, v40
    v_cvt_pk_bf16_f32 v18, v58, v59
    v_lshlrev_b32 v60, 16, v19
    v_and_b32 v61, 0xffff0000, v19
    v_fma_f32 v60, v60, v42, v40
    v_fma_f32 v61, v61, v42, v40
    v_cvt_pk_bf16_f32 v19, v60, v61
    ds_write_b128 v45, v[16:19] offset:16384
    v_lshlrev_b32 v58, 16, v20
    v_and_b32 v59, 0xffff0000, v20
    v_fma_f32 v58, v58, v42, v40
    v_fma_f32 v59, v59, v42, v40
    v_cvt_pk_bf16_f32 v20, v58, v59
    v_lshlrev_b32 v60, 16, v21
    v_and_b32 v61, 0xffff0000, v21
    v_fma_f32 v60, v60, v42, v40
    v_fma_f32 v61, v61, v42, v40
    v_cvt_pk_bf16_f32 v21, v60, v61
    v_lshlrev_b32 v58, 16, v22
    v_and_b32 v59, 0xffff0000, v22
    v_fma_f32 v58, v58, v42, v40
    v_fma_f32 v59, v59, v42, v40
    v_cvt_pk_bf16_f32 v22, v58, v59
    v_lshlrev_b32 v60, 16, v23
    v_and_b32 v61, 0xffff0000, v23
    v_fma_f32 v60, v60, v42, v40
    v_fma_f32 v61, v61, v42, v40
    v_cvt_pk_bf16_f32 v23, v60, v61
    ds_write_b128 v45, v[20:23] offset:24576
    s_waitcnt vmcnt(4) lgkmcnt(0)
    s_mov_b64 exec, 1
    ds_add_u32 v104, v105
    s_mov_b64 exec, -1
    s_mov_b32 s24, s12
    s_and_b32 s25, s13, 0xffff
    s_mov_b32 s26, 256
    s_mov_b32 s27, 0x20000
    v_mov_b32 v110, 0
    buffer_load_dwordx2 v[108:109], v110, s[24:27], 0 offen sc1
    s_cmp_eq_u32 s32, 0
    s_cbranch_scc0 kf_a1
    s_setprio 3
    v_lshlrev_b32 v51, 3, v3
    v_add_u32 v51, v51, v47
    v_lshlrev_b32 v51, 5, v51
    v_lshl_add_u32 v51, v48, 3, v51
    v_add_u32 v51, 102400, v51
    v_and_b32 v60, 1, v3
    v_lshlrev_b32 v60, 5, v60
    s_and_b32 s40, s39, 1
    s_lshl_b32 s40, s40, 4
    v_add3_u32 v60, v60, v4, s40
    v_xor_b32 v61, v60, v3
    v_xor_b32 v60, 4, v61
    v_lshlrev_b32 v62, 9, v3
    v_and_b32 v62, 0x400, v62
    s_bfe_u32 s40, s39, 0x10001
    s_lshl_b32 s40, s40, 15
    v_add_u32 v62, s40, v62
    v_lshl_add_u32 v61, v61, 4, v62
    v_lshl_add_u32 v60, v60, 4, v62
    v_and_b32 v62, 1, v3
    v_lshlrev_b32 v62, 9, v62
    v_lshl_add_u32 v62, v4, 4, v62
    v_lshrrev_b32 v63, 1, v3
    v_lshl_add_u32 v62, v63, 3, v62
    s_lshl_b32 s49, s38, 1
    s_bfe_u32 s40, s39, 0x10001
    s_add_u32 s49, s49, s40
    s_lshl_b32 s49, s49, 11
    s_add_u32 s49, s49, 4194304
    s_and_b32 s40, s39, 1
    s_lshl_b32 s40, s40, 8
    s_add_u32 s49, s49, s40
    s_lshr_b32 s40, s39, 2
    s_lshl_b32 s40, s40, 10
    s_add_u32 s49, s49, s40
2:
    ds_read_b32 v63, v104
    s_waitcnt lgkmcnt(0)
    v_readfirstlane_b32 s40, v63
    s_nop 0
    s_cmp_ge_u32 s40, 4
    s_cbranch_scc0 2b
    s_cmp_ge_u32 s39, 4
    s_cbranch_scc1 kf_v
    ds_read_b64_tr_b16 v[132:133], v51 offset:0
    ds_read_b64_tr_b16 v[134:135], v51 offset:128
    ds_read_b128 v[64:67], v61 offset:0
    ds_read_b64_tr_b16 v[140:141], v51 offset:1024
    ds_read_b64_tr_b16 v[142:143], v51 offset:1152
    ds_read_b128 v[68:71], v60 offset:2048
    ds_read_b64_tr_b16 v[148:149], v51 offset:2048
    ds_read_b64_tr_b16 v[150:151], v51 offset:2176
    ds_read_b128 v[72:75], v61 offset:4096
    ds_read_b64_tr_b16 v[156:157], v51 offset:3072
    ds_read_b64_tr_b16 v[158:159], v51 offset:3200
    ds_read_b128 v[76:79], v60 offset:6144
    ds_read_b64_tr_b16 v[164:165], v51 offset:4096
    ds_read_b64_tr_b16 v[166:167], v51 offset:4224
    ds_read_b128 v[80:83], v61 offset:8192
    s_waitcnt lgkmcnt(12)
    v_mfma_f32_16x16x32_bf16 v[96:99], v[132:135], v[64:67], 0
    ds_read_b64_tr_b16 v[172:173], v51 offset:5120
    ds_read_b64_tr_b16 v[174:175], v51 offset:5248
    ds_read_b128 v[84:87], v60 offset:10240
    s_waitcnt lgkmcnt(12)
    v_mfma_f32_16x16x32_bf16 v[100:103], v[140:143], v[68:71], 0
    ds_read_b64_tr_b16 v[180:181], v51 offset:6144
    ds_read_b64_tr_b16 v[182:183], v51 offset:6272
    ds_read_b128 v[88:91], v61 offset:12288
    s_waitcnt lgkmcnt(12)
    v_mfma_f32_16x16x32_bf16 v[96:99], v[148:151], v[72:75], v[96:99]
    ds_read_b64_tr_b16 v[188:189], v51 offset:7168
    ds_read_b64_tr_b16 v[190:191], v51 offset:7296
    ds_read_b128 v[92:95], v60 offset:14336
    s_waitcnt lgkmcnt(12)
    v_mfma_f32_16x16x32_bf16 v[100:103], v[156:159], v[76:79], v[100:103]
    ds_read_b64_tr_b16 v[196:197], v51 offset:8192
    ds_read_b64_tr_b16 v[198:199], v51 offset:8320
    ds_read_b128 v[64:67], v61 offset:16384
    s_waitcnt lgkmcnt(12)
    v_mfma_f32_16x16x32_bf16 v[96:99], v[164:167], v[80:83], v[96:99]
    ds_read_b64_tr_b16 v[204:205], v51 offset:9216
    ds_read_b64_tr_b16 v[206:207], v51 offset:9344
    ds_read_b128 v[68:71], v60 offset:18432
    s_waitcnt lgkmcnt(12)
    v_mfma_f32_16x16x32_bf16 v[100:103], v[172:175], v[84:87], v[100:103]
    ds_read_b64_tr_b16 v[212:213], v51 offset:10240
    ds_read_b64_tr_b16 v[214:215], v51 offset:10368
    ds_read_b128 v[72:75], v61 offset:20480
    s_waitcnt lgkmcnt(12)
    v_mfma_f32_16x16x32_bf16 v[96:99], v[180:183], v[88:91], v[96:99]
    ds_read_b64_tr_b16 v[220:221], v51 offset:11264
    ds_read_b64_tr_b16 v[222:223], v51 offset:11392
    ds_read_b128 v[76:79], v60 offset:22528
    s_waitcnt lgkmcnt(12)
    v_mfma_f32_16x16x32_bf16 v[100:103], v[188:191], v[92:95], v[100:103]
    ds_read_b64_tr_b16 v[228:229], v51 offset:12288
    ds_read_b64_tr_b16 v[230:231], v51 offset:12416
    ds_read_b128 v[80:83], v61 offset:24576
    s_waitcnt lgkmcnt(12)
    v_mfma_f32_16x16x32_bf16 v[96:99], v[196:199], v[64:67], v[96:99]
    ds_read_b64_tr_b16 v[236:237], v51 offset:13312
    ds_read_b64_tr_b16 v[238:239], v51 offset:13440
    ds_read_b128 v[84:87], v60 offset:26624
    s_waitcnt lgkmcnt(12)
    v_mfma_f32_16x16x32_bf16 v[100:103], v[204:207], v[68:71], v[100:103]
    ds_read_b64_tr_b16 v[244:245], v51 offset:14336
    ds_read_b64_tr_b16 v[246:247], v51 offset:14464
    ds_read_b128 v[88:91], v61 offset:28672
    s_waitcnt lgkmcnt(12)
    v_mfma_f32_16x16x32_bf16 v[96:99], v[212:215], v[72:75], v[96:99]
    ds_read_b64_tr_b16 v[252:253], v51 offset:15360
    ds_read_b64_tr_b16 v[254:255], v51 offset:15488
    ds_read_b128 v[92:95], v60 offset:30720
    s_waitcnt lgkmcnt(12)
    v_mfma_f32_16x16x32_bf16 v[100:103], v[220:223], v[76:79], v[100:103]
    s_waitcnt lgkmcnt(9)
    v_mfma_f32_16x16x32_bf16 v[96:99], v[228:231], v[80:83], v[96:99]
    s_waitcnt lgkmcnt(6)
    v_mfma_f32_16x16x32_bf16 v[100:103], v[236:239], v[84:87], v[100:103]
    s_waitcnt lgkmcnt(3)
    v_mfma_f32_16x16x32_bf16 v[96:99], v[244:247], v[88:91], v[96:99]
    s_waitcnt lgkmcnt(0)
    v_mfma_f32_16x16x32_bf16 v[100:103], v[252:255], v[92:95], v[100:103]
    s_branch kf_kvr
kf_v:
    ds_read_b64_tr_b16 v[132:133], v51 offset:0
    ds_read_b64_tr_b16 v[134:135], v51 offset:128
    ds_read_b128 v[64:67], v61 offset:0
    ds_read_b64_tr_b16 v[140:141], v51 offset:1024
    ds_read_b64_tr_b16 v[142:143], v51 offset:1152
    ds_read_b128 v[68:71], v60 offset:2048
    ds_read_b64_tr_b16 v[148:149], v51 offset:2048
    ds_read_b64_tr_b16 v[150:151], v51 offset:2176
    ds_read_b128 v[72:75], v61 offset:4096
    ds_read_b64_tr_b16 v[156:157], v51 offset:3072
    ds_read_b64_tr_b16 v[158:159], v51 offset:3200
    ds_read_b128 v[76:79], v60 offset:6144
    ds_read_b64_tr_b16 v[164:165], v51 offset:4096
    ds_read_b64_tr_b16 v[166:167], v51 offset:4224
    ds_read_b128 v[80:83], v61 offset:8192
    s_waitcnt lgkmcnt(12)
    v_mfma_f32_16x16x32_bf16 v[96:99], v[64:67], v[132:135], 0
    ds_read_b64_tr_b16 v[172:173], v51 offset:5120
    ds_read_b64_tr_b16 v[174:175], v51 offset:5248
    ds_read_b128 v[84:87], v60 offset:10240
    s_waitcnt lgkmcnt(12)
    v_mfma_f32_16x16x32_bf16 v[100:103], v[68:71], v[140:143], 0
    ds_read_b64_tr_b16 v[180:181], v51 offset:6144
    ds_read_b64_tr_b16 v[182:183], v51 offset:6272
    ds_read_b128 v[88:91], v61 offset:12288
    s_waitcnt lgkmcnt(12)
    v_mfma_f32_16x16x32_bf16 v[96:99], v[72:75], v[148:151], v[96:99]
    ds_read_b64_tr_b16 v[188:189], v51 offset:7168
    ds_read_b64_tr_b16 v[190:191], v51 offset:7296
    ds_read_b128 v[92:95], v60 offset:14336
    s_waitcnt lgkmcnt(12)
    v_mfma_f32_16x16x32_bf16 v[100:103], v[76:79], v[156:159], v[100:103]
    ds_read_b64_tr_b16 v[196:197], v51 offset:8192
    ds_read_b64_tr_b16 v[198:199], v51 offset:8320
    ds_read_b128 v[64:67], v61 offset:16384
    s_waitcnt lgkmcnt(12)
    v_mfma_f32_16x16x32_bf16 v[96:99], v[80:83], v[164:167], v[96:99]
    ds_read_b64_tr_b16 v[204:205], v51 offset:9216
    ds_read_b64_tr_b16 v[206:207], v51 offset:9344
    ds_read_b128 v[68:71], v60 offset:18432
    s_waitcnt lgkmcnt(12)
    v_mfma_f32_16x16x32_bf16 v[100:103], v[84:87], v[172:175], v[100:103]
    ds_read_b64_tr_b16 v[212:213], v51 offset:10240
    ds_read_b64_tr_b16 v[214:215], v51 offset:10368
    ds_read_b128 v[72:75], v61 offset:20480
    s_waitcnt lgkmcnt(12)
    v_mfma_f32_16x16x32_bf16 v[96:99], v[88:91], v[180:183], v[96:99]
    ds_read_b64_tr_b16 v[220:221], v51 offset:11264
    ds_read_b64_tr_b16 v[222:223], v51 offset:11392
    ds_read_b128 v[76:79], v60 offset:22528
    s_waitcnt lgkmcnt(12)
    v_mfma_f32_16x16x32_bf16 v[100:103], v[92:95], v[188:191], v[100:103]
    ds_read_b64_tr_b16 v[228:229], v51 offset:12288
    ds_read_b64_tr_b16 v[230:231], v51 offset:12416
    ds_read_b128 v[80:83], v61 offset:24576
    s_waitcnt lgkmcnt(12)
    v_mfma_f32_16x16x32_bf16 v[96:99], v[64:67], v[196:199], v[96:99]
    ds_read_b64_tr_b16 v[236:237], v51 offset:13312
    ds_read_b64_tr_b16 v[238:239], v51 offset:13440
    ds_read_b128 v[84:87], v60 offset:26624
    s_waitcnt lgkmcnt(12)
    v_mfma_f32_16x16x32_bf16 v[100:103], v[68:71], v[204:207], v[100:103]
    ds_read_b64_tr_b16 v[244:245], v51 offset:14336
    ds_read_b64_tr_b16 v[246:247], v51 offset:14464
    ds_read_b128 v[88:91], v61 offset:28672
    s_waitcnt lgkmcnt(12)
    v_mfma_f32_16x16x32_bf16 v[96:99], v[72:75], v[212:215], v[96:99]
    ds_read_b64_tr_b16 v[252:253], v51 offset:15360
    ds_read_b64_tr_b16 v[254:255], v51 offset:15488
    ds_read_b128 v[92:95], v60 offset:30720
    s_waitcnt lgkmcnt(12)
    v_mfma_f32_16x16x32_bf16 v[100:103], v[76:79], v[220:223], v[100:103]
    s_waitcnt lgkmcnt(9)
    v_mfma_f32_16x16x32_bf16 v[96:99], v[80:83], v[228:231], v[96:99]
    s_waitcnt lgkmcnt(6)
    v_mfma_f32_16x16x32_bf16 v[100:103], v[84:87], v[236:239], v[100:103]
    s_waitcnt lgkmcnt(3)
    v_mfma_f32_16x16x32_bf16 v[96:99], v[88:91], v[244:247], v[96:99]
    s_waitcnt lgkmcnt(0)
    v_mfma_f32_16x16x32_bf16 v[100:103], v[92:95], v[252:255], v[100:103]
kf_kvr:
    s_nop 7
    v_pk_add_f32 v[96:97], v[96:97], v[100:101]
    v_pk_add_f32 v[98:99], v[98:99], v[102:103]
    v_cvt_pk_bf16_f32 v96, v96, v97
    v_cvt_pk_bf16_f32 v97, v98, v99
    buffer_store_dwordx2 v[96:97], v62, s[28:31], s49 offen sc1
    s_setprio 0
kf_a1:
    v_mov_b32 v40, 0
    v_mov_b32 v41, 0
    v_mov_b32 v42, 0
    v_mov_b32 v43, 0
    s_waitcnt vmcnt(4)
    v_dot2c_f32_bf16 v40, v24, v44
    v_dot2c_f32_bf16 v42, v24, v24
    v_dot2c_f32_bf16 v41, v25, v44
    v_dot2c_f32_bf16 v43, v25, v25
    v_dot2c_f32_bf16 v40, v26, v44
    v_dot2c_f32_bf16 v42, v26, v26
    v_dot2c_f32_bf16 v41, v27, v44
    v_dot2c_f32_bf16 v43, v27, v27
    s_waitcnt vmcnt(3)
    v_dot2c_f32_bf16 v40, v28, v44
    v_dot2c_f32_bf16 v42, v28, v28
    v_dot2c_f32_bf16 v41, v29, v44
    v_dot2c_f32_bf16 v43, v29, v29
    v_dot2c_f32_bf16 v40, v30, v44
    v_dot2c_f32_bf16 v42, v30, v30
    v_dot2c_f32_bf16 v41, v31, v44
    v_dot2c_f32_bf16 v43, v31, v31
    s_waitcnt vmcnt(2)
    v_dot2c_f32_bf16 v40, v32, v44
    v_dot2c_f32_bf16 v42, v32, v32
    v_dot2c_f32_bf16 v41, v33, v44
    v_dot2c_f32_bf16 v43, v33, v33
    v_dot2c_f32_bf16 v40, v34, v44
    v_dot2c_f32_bf16 v42, v34, v34
    v_dot2c_f32_bf16 v41, v35, v44
    v_dot2c_f32_bf16 v43, v35, v35
    s_waitcnt vmcnt(1)
    v_dot2c_f32_bf16 v40, v36, v44
    v_dot2c_f32_bf16 v42, v36, v36
    v_dot2c_f32_bf16 v41, v37, v44
    v_dot2c_f32_bf16 v43, v37, v37
    v_dot2c_f32_bf16 v40, v38, v44
    v_dot2c_f32_bf16 v42, v38, v38
    v_dot2c_f32_bf16 v41, v39, v44
    v_dot2c_f32_bf16 v43, v39, v39
    s_nop 1
    v_add_f32 v40, v40, v41
    v_add_f32 v42, v42, v43
    s_nop 1
    v_add_f32_dpp v40, v40, v40 quad_perm:[1,0,3,2] row_mask:0xf bank_mask:0xf
    v_add_f32_dpp v42, v42, v42 quad_perm:[1,0,3,2] row_mask:0xf bank_mask:0xf
    s_nop 0
    v_add_f32_dpp v40, v40, v40 quad_perm:[2,3,0,1] row_mask:0xf bank_mask:0xf
    v_add_f32_dpp v42, v42, v42 quad_perm:[2,3,0,1] row_mask:0xf bank_mask:0xf
    s_nop 0
    v_add_f32_dpp v40, v40, v40 row_half_mirror row_mask:0xf bank_mask:0xf
    v_add_f32_dpp v42, v42, v42 row_half_mirror row_mask:0xf bank_mask:0xf
    s_nop 0
    v_add_f32_dpp v40, v40, v40 row_mirror row_mask:0xf bank_mask:0xf
    v_add_f32_dpp v42, v42, v42 row_mirror row_mask:0xf bank_mask:0xf
    v_mul_f32 v40, 0x3b000000, v40
    v_mul_f32 v42, 0x3b000000, v42
    v_fma_f32 v42, -v40, v40, v42
    v_max_f32 v42, 0, v42
    v_add_f32 v42, 0x3727c5ac, v42
    v_rsq_f32 v42, v42
    s_nop 0
    v_mul_f32 v40, v40, v42
    v_sub_f32 v40, 0, v40
    v_lshlrev_b32 v58, 16, v24
    v_and_b32 v59, 0xffff0000, v24
    v_fma_f32 v58, v58, v42, v40
    v_fma_f32 v59, v59, v42, v40
    v_cvt_pk_bf16_f32 v24, v58, v59
    v_lshlrev_b32 v60, 16, v25
    v_and_b32 v61, 0xffff0000, v25
    v_fma_f32 v60, v60, v42, v40
    v_fma_f32 v61, v61, v42, v40
    v_cvt_pk_bf16_f32 v25, v60, v61
    v_lshlrev_b32 v58, 16, v26
    v_and_b32 v59, 0xffff0000, v26
    v_fma_f32 v58, v58, v42, v40
    v_fma_f32 v59, v59, v42, v40
    v_cvt_pk_bf16_f32 v26, v58, v59
    v_lshlrev_b32 v60, 16, v27
    v_and_b32 v61, 0xffff0000, v27
    v_fma_f32 v60, v60, v42, v40
    v_fma_f32 v61, v61, v42, v40
    v_cvt_pk_bf16_f32 v27, v60, v61
    ds_write_b128 v7, v[24:27] offset:0
    v_lshlrev_b32 v58, 16, v28
    v_and_b32 v59, 0xffff0000, v28
    v_fma_f32 v58, v58, v42, v40
    v_fma_f32 v59, v59, v42, v40
    v_cvt_pk_bf16_f32 v28, v58, v59
    v_lshlrev_b32 v60, 16, v29
    v_and_b32 v61, 0xffff0000, v29
    v_fma_f32 v60, v60, v42, v40
    v_fma_f32 v61, v61, v42, v40
    v_cvt_pk_bf16_f32 v29, v60, v61
    v_lshlrev_b32 v58, 16, v30
    v_and_b32 v59, 0xffff0000, v30
    v_fma_f32 v58, v58, v42, v40
    v_fma_f32 v59, v59, v42, v40
    v_cvt_pk_bf16_f32 v30, v58, v59
    v_lshlrev_b32 v60, 16, v31
    v_and_b32 v61, 0xffff0000, v31
    v_fma_f32 v60, v60, v42, v40
    v_fma_f32 v61, v61, v42, v40
    v_cvt_pk_bf16_f32 v31, v60, v61
    ds_write_b128 v7, v[28:31] offset:8192
    v_lshlrev_b32 v58, 16, v32
    v_and_b32 v59, 0xffff0000, v32
    v_fma_f32 v58, v58, v42, v40
    v_fma_f32 v59, v59, v42, v40
    v_cvt_pk_bf16_f32 v32, v58, v59
    v_lshlrev_b32 v60, 16, v33
    v_and_b32 v61, 0xffff0000, v33
    v_fma_f32 v60, v60, v42, v40
    v_fma_f32 v61, v61, v42, v40
    v_cvt_pk_bf16_f32 v33, v60, v61
    v_lshlrev_b32 v58, 16, v34
    v_and_b32 v59, 0xffff0000, v34
    v_fma_f32 v58, v58, v42, v40
    v_fma_f32 v59, v59, v42, v40
    v_cvt_pk_bf16_f32 v34, v58, v59
    v_lshlrev_b32 v60, 16, v35
    v_and_b32 v61, 0xffff0000, v35
    v_fma_f32 v60, v60, v42, v40
    v_fma_f32 v61, v61, v42, v40
    v_cvt_pk_bf16_f32 v35, v60, v61
    ds_write_b128 v7, v[32:35] offset:16384
    v_lshlrev_b32 v58, 16, v36
    v_and_b32 v59, 0xffff0000, v36
    v_fma_f32 v58, v58, v42, v40
    v_fma_f32 v59, v59, v42, v40
    v_cvt_pk_bf16_f32 v36, v58, v59
    v_lshlrev_b32 v60, 16, v37
    v_and_b32 v61, 0xffff0000, v37
    v_fma_f32 v60, v60, v42, v40
    v_fma_f32 v61, v61, v42, v40
    v_cvt_pk_bf16_f32 v37, v60, v61
    v_lshlrev_b32 v58, 16, v38
    v_and_b32 v59, 0xffff0000, v38
    v_fma_f32 v58, v58, v42, v40
    v_fma_f32 v59, v59, v42, v40
    v_cvt_pk_bf16_f32 v38, v58, v59
    v_lshlrev_b32 v60, 16, v39
    v_and_b32 v61, 0xffff0000, v39
    v_fma_f32 v60, v60, v42, v40
    v_fma_f32 v61, v61, v42, v40
    v_cvt_pk_bf16_f32 v39, v60, v61
    ds_write_b128 v7, v[36:39] offset:24576
    s_cmp_eq_u32 s32, 0
    s_cbranch_scc0 kf_a2
    s_waitcnt vmcnt(0)
    s_call_b64 s[60:61], kf_pubkv
kf_a2:
    v_mov_b32 v104, 100412
    s_waitcnt lgkmcnt(0)
    s_mov_b64 exec, 1
    ds_add_u32 v104, v105
    s_mov_b64 exec, -1
    v_mov_b32 v57, v2
    v_lshrrev_b32 v64, 1, v2
    v_lshlrev_b32 v64, 7, v64
    v_and_b32 v60, 1, v2
    v_lshl_add_u32 v64, v60, 5, v64
    s_and_b32 s40, s2, 7
    s_lshl_b32 s40, s40, 12
    s_add_u32 s40, s40, 4456448
    v_add_u32 v64, s40, v64
    v_mov_b32 v65, 100400
    v_add_u32 v7, 4194304, v56
    s_lshl_b32 s56, s32, 15
    s_lshr_b32 s41, s2, 3
    s_lshl_b32 s41, s41, 12
    s_add_u32 s56, s56, s41
    s_lshl_b32 s45, s32, 12
    s_add_u32 s45, s45, 102400
    v_add_u32 v0, s45, v56
    v_add_u32 v1, 81920, v56
    s_lshl_b32 s46, s32, 2
    s_add_u32 s46, s46, 82944
    v_add_u32 v2, s46, v56
    s_lshl_b32 s46, s32, 11
    s_add_u32 s46, s46, 65536
    v_add_u32 v3, s46, v56
    v_mov_b32 v4, 0x3f80
    v_mov_b32 v5, 0
    v_mov_b32 v59, 0
    s_mov_b32 exec_lo, 0
    v_mov_b32 v4, 0
    s_mov_b32 exec_lo, 0x00110011
    s_mov_b32 exec_hi, 0x00110011
    v_mov_b32 v59, 0x3f803f80
    s_mov_b64 exec, -1
    s_mov_b32 s50, 0x71800000
    s_mov_b32 s51, 8192
    s_mov_b32 s52, 2048
    s_mov_b32 s53, 0
    s_mov_b32 s49, -1
    v_mov_b32 v132, v59
    v_mov_b32 v133, v59
    v_mov_b32 v134, v59
    v_mov_b32 v135, v59
    v_mov_b32 v140, v59
    v_mov_b32 v141, v59
    v_mov_b32 v142, v59
    v_mov_b32 v143, v59
    v_mov_b32 v148, v59
    v_mov_b32 v149, v59
    v_mov_b32 v150, v59
    v_mov_b32 v151, v59
    v_mov_b32 v156, v59
    v_mov_b32 v157, v59
    v_mov_b32 v158, v59
    v_mov_b32 v159, v59
    v_mov_b32 v164, v59
    v_mov_b32 v165, v59
    v_mov_b32 v166, v59
    v_mov_b32 v167, v59
    v_mov_b32 v172, v59
    v_mov_b32 v173, v59
    v_mov_b32 v174, v59
    v_mov_b32 v175, v59
    v_mov_b32 v180, v59
    v_mov_b32 v181, v59
    v_mov_b32 v182, v59
    v_mov_b32 v183, v59
    v_mov_b32 v188, v59
    v_mov_b32 v189, v59
    v_mov_b32 v190, v59
    v_mov_b32 v191, v59
    v_mov_b32 v196, v59
    v_mov_b32 v197, v59
    v_mov_b32 v198, v59
    v_mov_b32 v199, v59
    v_mov_b32 v204, v59
    v_mov_b32 v205, v59
    v_mov_b32 v206, v59
    v_mov_b32 v207, v59
    v_mov_b32 v212, v59
    v_mov_b32 v213, v59
    v_mov_b32 v214, v59
    v_mov_b32 v215, v59
    v_mov_b32 v220, v59
    v_mov_b32 v221, v59
    v_mov_b32 v222, v59
    v_mov_b32 v223, v59
    v_mov_b32 v228, v59
    v_mov_b32 v229, v59
    v_mov_b32 v230, v59
    v_mov_b32 v231, v59
    v_mov_b32 v236, v59
    v_mov_b32 v237, v59
    v_mov_b32 v238, v59
    v_mov_b32 v239, v59
    v_mov_b32 v244, v59
    v_mov_b32 v245, v59
    v_mov_b32 v246, v59
    v_mov_b32 v247, v59
    v_mov_b32 v252, v59
    v_mov_b32 v253, v59
    v_mov_b32 v254, v59
    v_mov_b32 v255, v59
    s_setprio 2
    s_cmp_eq_u32 s32, 1
    s_cbranch_scc0 6f
    s_waitcnt vmcnt(0)
7:
    v_readfirstlane_b32 s74, v108
    v_readfirstlane_b32 s75, v109
    s_cmp_lg_u32 s74, 0
    s_cbranch_scc1 8f
    s_sleep 2
    buffer_load_dwordx2 v[108:109], v110, s[24:27], 0 offen sc1
    s_waitcnt vmcnt(0)
    s_branch 7b
8:
    v_mov_b32 v67, 100412
2:
    s_sleep 1
    ds_read_b32 v66, v67
    s_waitcnt lgkmcnt(0)
    v_readfirstlane_b32 s40, v66
    s_nop 0
    s_cmp_ge_u32 s40, 8
    s_cbranch_scc0 2b
    buffer_load_dwordx4 v[16:19], v64, s[28:31], 0 offen sc1
    buffer_load_dwordx4 v[20:23], v64, s[28:31], 0 offen offset:16 sc1
    s_sleep 4
3:
    buffer_load_dwordx4 v[24:27], v64, s[28:31], 0 offen sc1
    buffer_load_dwordx4 v[28:31], v64, s[28:31], 0 offen offset:16 sc1
    s_waitcnt vmcnt(2)
    v_xor_b32 v16, s74, v16
    v_xor_b32 v17, s75, v17
    v_xor_b32 v18, s74, v18
    v_xor_b32 v19, s75, v19
    v_xor_b32 v20, s74, v20
    v_xor_b32 v21, s75, v21
    v_xor_b32 v22, s74, v22
    v_xor_b32 v23, s75, v23
    v_or3_b32 v16, v16, v17, v18
    v_or3_b32 v20, v20, v21, v22
    v_or3_b32 v16, v16, v19, v23
    v_or_b32 v16, v16, v20
    v_cmp_ne_u32 vcc, 0, v16
    s_nop 0
    s_cbranch_vccz 5f
    buffer_load_dwordx4 v[16:19], v64, s[28:31], 0 offen sc1
    buffer_load_dwordx4 v[20:23], v64, s[28:31], 0 offen offset:16 sc1
    s_waitcnt vmcnt(2)
    v_xor_b32 v24, s74, v24
    v_xor_b32 v25, s75, v25
    v_xor_b32 v26, s74, v26
    v_xor_b32 v27, s75, v27
    v_xor_b32 v28, s74, v28
    v_xor_b32 v29, s75, v29
    v_xor_b32 v30, s74, v30
    v_xor_b32 v31, s75, v31
    v_or3_b32 v24, v24, v25, v26
    v_or3_b32 v28, v28, v29, v30
    v_or3_b32 v24, v24, v27, v31
    v_or_b32 v24, v24, v28
    v_cmp_ne_u32 vcc, 0, v24
    s_nop 0
    s_cbranch_vccz 5f
    s_branch 3b
5:
    v_mov_b32 v66, 1
    ds_write_b32 v65, v66
    s_branch 4f
6:
    ds_read_b32 v66, v65
    s_waitcnt lgkmcnt(0)
    v_readfirstlane_b32 s40, v66
    s_nop 0
    s_cmp_eq_u32 s40, 0
    s_cbranch_scc0 4f
    s_sleep 1
    s_branch 6b
4:
    s_add_u32 s58, s56, 0
    s_and_b32 s58, s58, 0x1ffff
    buffer_load_dwordx4 v[80:83], v7, s[28:31], s58 offen sc1
    s_add_u32 s58, s56, 2048
    s_and_b32 s58, s58, 0x1ffff
    buffer_load_dwordx4 v[84:87], v7, s[28:31], s58 offen sc1
    s_add_u32 m0, s45, 0
    s_add_u32 s58, s56, 4096
    s_and_b32 s58, s58, 0x1ffff
    buffer_load_dwordx4 v7, s[28:31], s58 offen sc1 lds
    s_add_u32 s58, s56, 0
    s_and_b32 s58, s58, 0x1ffff
    buffer_load_dwordx4 v[128:131], v7, s[28:31], s58 offen offset:1024 sc1
    s_add_u32 s58, s56, 2048
    s_and_b32 s58, s58, 0x1ffff
    buffer_load_dwordx4 v[136:139], v7, s[28:31], s58 offen offset:1024 sc1
    s_add_u32 s58, s56, 6144
    s_and_b32 s58, s58, 0x1ffff
    buffer_load_dwordx4 v[88:91], v7, s[28:31], s58 offen sc1
    s_add_u32 s58, s56, 4096
    s_and_b32 s58, s58, 0x1ffff
    buffer_load_dwordx4 v[144:147], v7, s[28:31], s58 offen offset:1024 sc1
    s_add_u32 s58, s56, 8192
    s_and_b32 s58, s58, 0x1ffff
    buffer_load_dwordx4 v[92:95], v7, s[28:31], s58 offen sc1
    s_add_u32 m0, s45, 1024
    s_add_u32 s58, s56, 12288
    s_and_b32 s58, s58, 0x1ffff
    buffer_load_dwordx4 v7, s[28:31], s58 offen sc1 lds
    s_add_u32 s58, s56, 6144
    s_and_b32 s58, s58, 0x1ffff
    buffer_load_dwordx4 v[152:155], v7, s[28:31], s58 offen offset:1024 sc1
    s_add_u32 s58, s56, 10240
    s_and_b32 s58, s58, 0x1ffff
    buffer_load_dwordx4 v[96:99], v7, s[28:31], s58 offen sc1
    s_add_u32 s58, s56, 8192
    s_and_b32 s58, s58, 0x1ffff
    buffer_load_dwordx4 v[160:163], v7, s[28:31], s58 offen offset:1024 sc1
    s_add_u32 s58, s56, 10240
    s_and_b32 s58, s58, 0x1ffff
    buffer_load_dwordx4 v[168:171], v7, s[28:31], s58 offen offset:1024 sc1
    s_add_u32 s58, s56, 14336
    s_and_b32 s58, s58, 0x1ffff
    buffer_load_dwordx4 v[100:103], v7, s[28:31], s58 offen sc1
    s_add_u32 s58, s56, 12288
    s_and_b32 s58, s58, 0x1ffff
    buffer_load_dwordx4 v[176:179], v7, s[28:31], s58 offen offset:1024 sc1
    s_add_u32 s58, s56, 16384
    s_and_b32 s58, s58, 0x1ffff
    buffer_load_dwordx4 v[104:107], v7, s[28:31], s58 offen sc1
    s_add_u32 m0, s45, 2048
    s_add_u32 s58, s56, 20480
    s_and_b32 s58, s58, 0x1ffff
    buffer_load_dwordx4 v7, s[28:31], s58 offen sc1 lds
    s_add_u32 s58, s56, 14336
    s_and_b32 s58, s58, 0x1ffff
    buffer_load_dwordx4 v[184:187], v7, s[28:31], s58 offen offset:1024 sc1
    s_add_u32 s58, s56, 18432
    s_and_b32 s58, s58, 0x1ffff
    buffer_load_dwordx4 v[108:111], v7, s[28:31], s58 offen sc1
    s_add_u32 s58, s56, 16384
    s_and_b32 s58, s58, 0x1ffff
    buffer_load_dwordx4 v[192:195], v7, s[28:31], s58 offen offset:1024 sc1
    v_mov_b32 v65, 100404
    s_lshl_b32 s40, s32, 11
    v_add_u32 v66, s40, v1
    s_add_u32 s48, s32, 4
2:
    ds_read_b32 v67, v65
    ds_read_b128 v[48:51], v66
    ds_read_b128 v[52:55], v66 offset:8192
    s_waitcnt lgkmcnt(0)
    v_readfirstlane_b32 s40, v67
    s_nop 0
    s_cmp_ge_u32 s40, 4
    s_cbranch_scc0 2b
    s_waitcnt vmcnt(18)
    v_mfma_f32_32x32x16_bf16 v[16:31], v[80:83], v[48:51], 0
    v_mfma_f32_32x32x16_bf16 v[32:47], v[84:87], v[48:51], 0
    s_lshl_b32 s40, s32, 11
    s_add_u32 s40, s40, 81920
    v_add_u32 v68, s40, v56
    s_lshl_b32 s41, s32, 7
    s_add_u32 s41, s41, 98304
    v_and_b32 v69, 31, v57
    v_lshl_add_u32 v69, v69, 2, s41
    s_nop 3
    v_max3_f32 v64, v16, v17, v18
    v_max3_f32 v65, v19, v20, v21
    v_max3_f32 v64, v22, v23, v64
    v_max3_f32 v65, v24, v25, v65
    v_max3_f32 v64, v26, v27, v64
    v_max3_f32 v65, v28, v29, v65
    v_max3_f32 v64, v30, v31, v64
    v_max3_f32 v65, v32, v33, v65
    v_max3_f32 v64, v34, v35, v64
    v_max3_f32 v65, v36, v37, v65
    v_max3_f32 v64, v38, v39, v64
    v_max3_f32 v65, v40, v41, v65
    v_max3_f32 v64, v42, v43, v64
    v_max3_f32 v65, v44, v45, v65
    v_max3_f32 v64, v46, v47, v64
    v_max_f32 v64, v64, v65
    v_mov_b32 v65, v64
    s_nop 1
    v_permlane32_swap_b32 v64, v65
    v_max_f32 v64, v64, v65
    v_add_f32 v64, 0x42b40000, v64
    v_mul_f32 v65, 0x3c800000, v64
    v_sub_f32 v64, abs(v65), v64
    v_cvt_pk_bf16_f32 v64, v64, -1.0
    ds_write_b32 v69, v64
    s_cmp_lt_u32 s32, 2
    s_cbranch_scc0 1f
    v_mov_b32 v65, v64
    v_mov_b32 v66, v64
    v_mov_b32 v67, v64
    ds_write_b128 v68, v[64:67] offset:1024
1:
    v_mfma_f32_32x32x16_bf16 v[16:31], v[80:83], v[52:55], 0
    v_mfma_f32_32x32x16_bf16 v[32:47], v[84:87], v[52:55], 0
    s_lshl_b32 s40, s48, 11
    s_add_u32 s40, s40, 81920
    v_add_u32 v68, s40, v56
    s_lshl_b32 s41, s48, 7
    s_add_u32 s41, s41, 98304
    v_and_b32 v69, 31, v57
    v_lshl_add_u32 v69, v69, 2, s41
    s_nop 3
    v_max3_f32 v64, v16, v17, v18
    v_max3_f32 v65, v19, v20, v21
    v_max3_f32 v64, v22, v23, v64
    v_max3_f32 v65, v24, v25, v65
    v_max3_f32 v64, v26, v27, v64
    v_max3_f32 v65, v28, v29, v65
    v_max3_f32 v64, v30, v31, v64
    v_max3_f32 v65, v32, v33, v65
    v_max3_f32 v64, v34, v35, v64
    v_max3_f32 v65, v36, v37, v65
    v_max3_f32 v64, v38, v39, v64
    v_max3_f32 v65, v40, v41, v65
    v_max3_f32 v64, v42, v43, v64
    v_max3_f32 v65, v44, v45, v65
    v_max3_f32 v64, v46, v47, v64
    v_max_f32 v64, v64, v65
    v_mov_b32 v65, v64
    s_nop 1
    v_permlane32_swap_b32 v64, v65
    v_max_f32 v64, v64, v65
    v_add_f32 v64, 0x42b40000, v64
    v_mul_f32 v65, 0x3c800000, v64
    v_sub_f32 v64, abs(v65), v64
    v_cvt_pk_bf16_f32 v64, v64, -1.0
    ds_write_b32 v69, v64
    s_cmp_lt_u32 s48, 2
    s_cbranch_scc0 1f
    v_mov_b32 v65, v64
    v_mov_b32 v66, v64
    v_mov_b32 v67, v64
    ds_write_b128 v68, v[64:67] offset:1024
1:
5:
    ds_read_b32 v6, v2
    ds_read_b128 v[8:11], v1
    s_waitcnt lgkmcnt(0)
    v_cmp_eq_u32 vcc, -1, v6
    s_nop 0
    s_cbranch_vccnz 5b
    v_mfma_f32_32x32x8_bf16 v[48:63], v[4:5], v[6:7], 0
    v_mfma_f32_32x32x16_bf16 v[16:31], v[80:83], v[8:11], v[48:63]
    s_nop 11
    v_exp_f32 v16, v16
    v_exp_f32 v17, v17
    v_exp_f32 v18, v18
    v_exp_f32 v19, v19
    v_cvt_pk_bf16_f32 v16, v16, v17
    v_exp_f32 v20, v20
    v_exp_f32 v21, v21
    v_cvt_pk_bf16_f32 v17, v18, v19
    v_exp_f32 v22, v22
    s_waitcnt vmcnt(16)
    v_mfma_f32_32x32x16_bf16 v[32:47], v[84:87], v[8:11], v[48:63]
    v_permlane16_swap_b32 v128, v132
    v_permlane16_swap_b32 v129, v133
    v_permlane16_swap_b32 v130, v134
    v_permlane16_swap_b32 v131, v135
    s_add_u32 s58, s56, 18432
    s_and_b32 s58, s58, 0x1ffff
    buffer_load_dwordx4 v[200:203], v7, s[28:31], s58 offen offset:1024 sc1
    s_add_u32 s58, s56, 22528
    s_and_b32 s58, s58, 0x1ffff
    buffer_load_dwordx4 v[112:115], v7, s[28:31], s58 offen sc1
    s_add_u32 s58, s56, 20480
    s_and_b32 s58, s58, 0x1ffff
    buffer_load_dwordx4 v[208:211], v7, s[28:31], s58 offen offset:1024 sc1
    s_add_u32 s58, s56, 24576
    s_and_b32 s58, s58, 0x1ffff
    buffer_load_dwordx4 v[116:119], v7, s[28:31], s58 offen sc1
    s_add_u32 m0, s45, 3072
    s_add_u32 s58, s56, 28672
    s_and_b32 s58, s58, 0x1ffff
    buffer_load_dwordx4 v7, s[28:31], s58 offen sc1 lds
    s_add_u32 s58, s56, 22528
    s_and_b32 s58, s58, 0x1ffff
    buffer_load_dwordx4 v[216:219], v7, s[28:31], s58 offen offset:1024 sc1
    v_exp_f32 v23, v23
    v_cvt_pk_bf16_f32 v18, v20, v21
    v_exp_f32 v24, v24
    v_exp_f32 v25, v25
    v_cvt_pk_bf16_f32 v19, v22, v23
    v_exp_f32 v26, v26
    v_exp_f32 v27, v27
    ds_read_b128 v[12:15], v0 offset:0
    v_mfma_f32_32x32x16_bf16 v[64:79], v[128:131], v[16:19], 0
    v_cvt_pk_bf16_f32 v20, v24, v25
    v_exp_f32 v28, v28
    v_exp_f32 v29, v29
    v_cvt_pk_bf16_f32 v21, v26, v27
    v_exp_f32 v30, v30
    v_exp_f32 v31, v31
    v_cvt_pk_bf16_f32 v22, v28, v29
    v_cvt_pk_bf16_f32 v23, v30, v31
    v_exp_f32 v32, v32
    v_exp_f32 v33, v33
    v_mfma_f32_32x32x16_bf16 v[64:79], v[132:135], v[20:23], v[64:79]
    v_exp_f32 v34, v34
    v_exp_f32 v35, v35
    v_cvt_pk_bf16_f32 v32, v32, v33
    v_exp_f32 v36, v36
    v_exp_f32 v37, v37
    v_cvt_pk_bf16_f32 v33, v34, v35
    v_exp_f32 v38, v38
    s_waitcnt lgkmcnt(0) vmcnt(21)
    v_mfma_f32_32x32x16_bf16 v[16:31], v[12:15], v[8:11], v[48:63]
    v_permlane16_swap_b32 v136, v140
    v_permlane16_swap_b32 v137, v141
    v_permlane16_swap_b32 v138, v142
    v_permlane16_swap_b32 v139, v143
    s_add_u32 s58, s56, 26624
    s_and_b32 s58, s58, 0x1ffff
    buffer_load_dwordx4 v[120:123], v7, s[28:31], s58 offen sc1
    s_add_u32 s58, s56, 24576
    s_and_b32 s58, s58, 0x1ffff
    buffer_load_dwordx4 v[224:227], v7, s[28:31], s58 offen offset:1024 sc1
    s_add_u32 s58, s56, 26624
    s_and_b32 s58, s58, 0x1ffff
    buffer_load_dwordx4 v[232:235], v7, s[28:31], s58 offen offset:1024 sc1
    s_add_u32 s58, s56, 30720
    s_and_b32 s58, s58, 0x1ffff
    buffer_load_dwordx4 v[124:127], v7, s[28:31], s58 offen sc1
    s_add_u32 s58, s56, 28672
    s_and_b32 s58, s58, 0x1ffff
    buffer_load_dwordx4 v[240:243], v7, s[28:31], s58 offen offset:1024 sc1
    s_add_u32 s58, s56, 30720
    s_and_b32 s58, s58, 0x1ffff
    buffer_load_dwordx4 v[248:251], v7, s[28:31], s58 offen offset:1024 sc1
    s_mov_b64 exec, 1
    ds_write_b32 v2, v4 offset:17488
    s_mov_b64 exec, -1
    v_exp_f32 v39, v39
    v_cvt_pk_bf16_f32 v34, v36, v37
    v_exp_f32 v40, v40
    v_exp_f32 v41, v41
    v_cvt_pk_bf16_f32 v35, v38, v39
    v_exp_f32 v42, v42
    v_exp_f32 v43, v43
    v_mfma_f32_32x32x16_bf16 v[64:79], v[136:139], v[32:35], v[64:79]
    v_cvt_pk_bf16_f32 v36, v40, v41
    v_exp_f32 v44, v44
    v_exp_f32 v45, v45
    v_cvt_pk_bf16_f32 v37, v42, v43
    v_exp_f32 v46, v46
    v_exp_f32 v47, v47
    v_cvt_pk_bf16_f32 v38, v44, v45
    v_cvt_pk_bf16_f32 v39, v46, v47
    v_exp_f32 v16, v16
    v_exp_f32 v17, v17
    v_mfma_f32_32x32x16_bf16 v[64:79], v[140:143], v[36:39], v[64:79]
    v_exp_f32 v18, v18
    v_exp_f32 v19, v19
    v_cvt_pk_bf16_f32 v16, v16, v17
    v_exp_f32 v20, v20
    v_exp_f32 v21, v21
    v_cvt_pk_bf16_f32 v17, v18, v19
    v_exp_f32 v22, v22
    s_waitcnt vmcnt(25)
    v_mfma_f32_32x32x16_bf16 v[32:47], v[88:91], v[8:11], v[48:63]
    v_permlane16_swap_b32 v144, v148
    v_permlane16_swap_b32 v145, v149
    v_permlane16_swap_b32 v146, v150
    v_permlane16_swap_b32 v147, v151
    v_exp_f32 v23, v23
    v_cvt_pk_bf16_f32 v18, v20, v21
    v_exp_f32 v24, v24
    v_exp_f32 v25, v25
    v_cvt_pk_bf16_f32 v19, v22, v23
    v_exp_f32 v26, v26
    v_exp_f32 v27, v27
    v_mfma_f32_32x32x16_bf16 v[64:79], v[144:147], v[16:19], v[64:79]
    v_cvt_pk_bf16_f32 v20, v24, v25
    v_exp_f32 v28, v28
    v_exp_f32 v29, v29
    v_cvt_pk_bf16_f32 v21, v26, v27
    v_exp_f32 v30, v30
    v_exp_f32 v31, v31
    v_cvt_pk_bf16_f32 v22, v28, v29
    v_cvt_pk_bf16_f32 v23, v30, v31
    v_exp_f32 v32, v32
    v_exp_f32 v33, v33
    v_mfma_f32_32x32x16_bf16 v[64:79], v[148:151], v[20:23], v[64:79]
    v_exp_f32 v34, v34
    v_exp_f32 v35, v35
    v_cvt_pk_bf16_f32 v32, v32, v33
    v_exp_f32 v36, v36
    v_exp_f32 v37, v37
    v_cvt_pk_bf16_f32 v33, v34, v35
    v_exp_f32 v38, v38
    s_waitcnt vmcnt(22)
    v_mfma_f32_32x32x16_bf16 v[16:31], v[92:95], v[8:11], v[48:63]
    v_permlane16_swap_b32 v152, v156
    v_permlane16_swap_b32 v153, v157
    v_permlane16_swap_b32 v154, v158
    v_permlane16_swap_b32 v155, v159
    v_exp_f32 v39, v39
    v_cvt_pk_bf16_f32 v34, v36, v37
    v_exp_f32 v40, v40
    v_exp_f32 v41, v41
    v_cvt_pk_bf16_f32 v35, v38, v39
    v_exp_f32 v42, v42
    v_exp_f32 v43, v43
    v_mfma_f32_32x32x16_bf16 v[64:79], v[152:155], v[32:35], v[64:79]
    v_cvt_pk_bf16_f32 v36, v40, v41
    v_exp_f32 v44, v44
    v_exp_f32 v45, v45
    v_cvt_pk_bf16_f32 v37, v42, v43
    v_exp_f32 v46, v46
    v_exp_f32 v47, v47
    v_cvt_pk_bf16_f32 v38, v44, v45
    v_cvt_pk_bf16_f32 v39, v46, v47
    ds_read_b128 v[12:15], v0 offset:1024
    v_exp_f32 v16, v16
    v_exp_f32 v17, v17
    v_mfma_f32_32x32x16_bf16 v[64:79], v[156:159], v[36:39], v[64:79]
    v_exp_f32 v18, v18
    v_exp_f32 v19, v19
    v_cvt_pk_bf16_f32 v16, v16, v17
    v_exp_f32 v20, v20
    v_exp_f32 v21, v21
    v_cvt_pk_bf16_f32 v17, v18, v19
    v_exp_f32 v22, v22
    s_waitcnt vmcnt(20)
    v_mfma_f32_32x32x16_bf16 v[32:47], v[96:99], v[8:11], v[48:63]
    v_permlane16_swap_b32 v160, v164
    v_permlane16_swap_b32 v161, v165
    v_permlane16_swap_b32 v162, v166
    v_permlane16_swap_b32 v163, v167
    v_exp_f32 v23, v23
    v_cvt_pk_bf16_f32 v18, v20, v21
    v_exp_f32 v24, v24
    v_exp_f32 v25, v25
    v_cvt_pk_bf16_f32 v19, v22, v23
    v_exp_f32 v26, v26
    v_exp_f32 v27, v27
    v_mfma_f32_32x32x16_bf16 v[64:79], v[160:163], v[16:19], v[64:79]
    v_cvt_pk_bf16_f32 v20, v24, v25
    v_exp_f32 v28, v28
    v_exp_f32 v29, v29
    v_cvt_pk_bf16_f32 v21, v26, v27
    v_exp_f32 v30, v30
    v_exp_f32 v31, v31
    v_cvt_pk_bf16_f32 v22, v28, v29
    v_cvt_pk_bf16_f32 v23, v30, v31
    v_exp_f32 v32, v32
    v_exp_f32 v33, v33
    v_mfma_f32_32x32x16_bf16 v[64:79], v[164:167], v[20:23], v[64:79]
    v_exp_f32 v34, v34
    v_exp_f32 v35, v35
    v_cvt_pk_bf16_f32 v32, v32, v33
    v_exp_f32 v36, v36
    v_exp_f32 v37, v37
    v_cvt_pk_bf16_f32 v33, v34, v35
    v_exp_f32 v38, v38
    s_waitcnt lgkmcnt(0) vmcnt(19)
    v_mfma_f32_32x32x16_bf16 v[16:31], v[12:15], v[8:11], v[48:63]
    v_permlane16_swap_b32 v168, v172
    v_permlane16_swap_b32 v169, v173
    v_permlane16_swap_b32 v170, v174
    v_permlane16_swap_b32 v171, v175
    v_exp_f32 v39, v39
    v_cvt_pk_bf16_f32 v34, v36, v37
    v_exp_f32 v40, v40
    v_exp_f32 v41, v41
    v_cvt_pk_bf16_f32 v35, v38, v39
    v_exp_f32 v42, v42
    v_exp_f32 v43, v43
    v_mfma_f32_32x32x16_bf16 v[64:79], v[168:171], v[32:35], v[64:79]
    v_cvt_pk_bf16_f32 v36, v40, v41
    v_exp_f32 v44, v44
    v_exp_f32 v45, v45
    v_cvt_pk_bf16_f32 v37, v42, v43
    v_exp_f32 v46, v46
    v_exp_f32 v47, v47
    v_cvt_pk_bf16_f32 v38, v44, v45
    v_cvt_pk_bf16_f32 v39, v46, v47
    v_exp_f32 v16, v16
    v_exp_f32 v17, v17
    v_mfma_f32_32x32x16_bf16 v[64:79], v[172:175], v[36:39], v[64:79]
    v_exp_f32 v18, v18
    v_exp_f32 v19, v19
    v_cvt_pk_bf16_f32 v16, v16, v17
    v_exp_f32 v20, v20
    v_exp_f32 v21, v21
    v_cvt_pk_bf16_f32 v17, v18, v19
    v_exp_f32 v22, v22
    s_waitcnt vmcnt(17)
    v_mfma_f32_32x32x16_bf16 v[32:47], v[100:103], v[8:11], v[48:63]
    v_permlane16_swap_b32 v176, v180
    v_permlane16_swap_b32 v177, v181
    v_permlane16_swap_b32 v178, v182
    v_permlane16_swap_b32 v179, v183
    v_exp_f32 v23, v23
    v_cvt_pk_bf16_f32 v18, v20, v21
    v_exp_f32 v24, v24
    v_exp_f32 v25, v25
    v_cvt_pk_bf16_f32 v19, v22, v23
    v_exp_f32 v26, v26
    v_exp_f32 v27, v27
    v_mfma_f32_32x32x16_bf16 v[64:79], v[176:179], v[16:19], v[64:79]
    v_cvt_pk_bf16_f32 v20, v24, v25
    v_exp_f32 v28, v28
    v_exp_f32 v29, v29
    v_cvt_pk_bf16_f32 v21, v26, v27
    v_exp_f32 v30, v30
    v_exp_f32 v31, v31
    v_cvt_pk_bf16_f32 v22, v28, v29
    v_cvt_pk_bf16_f32 v23, v30, v31
    v_exp_f32 v32, v32
    v_exp_f32 v33, v33
    v_mfma_f32_32x32x16_bf16 v[64:79], v[180:183], v[20:23], v[64:79]
    v_exp_f32 v34, v34
    v_exp_f32 v35, v35
    v_cvt_pk_bf16_f32 v32, v32, v33
    v_exp_f32 v36, v36
    v_exp_f32 v37, v37
    v_cvt_pk_bf16_f32 v33, v34, v35
    v_exp_f32 v38, v38
    s_waitcnt vmcnt(14)
    v_mfma_f32_32x32x16_bf16 v[16:31], v[104:107], v[8:11], v[48:63]
    v_permlane16_swap_b32 v184, v188
    v_permlane16_swap_b32 v185, v189
    v_permlane16_swap_b32 v186, v190
    v_permlane16_swap_b32 v187, v191
    v_exp_f32 v39, v39
    v_cvt_pk_bf16_f32 v34, v36, v37
    v_exp_f32 v40, v40
    v_exp_f32 v41, v41
    v_cvt_pk_bf16_f32 v35, v38, v39
    v_exp_f32 v42, v42
    v_exp_f32 v43, v43
    v_mfma_f32_32x32x16_bf16 v[64:79], v[184:187], v[32:35], v[64:79]
    v_cvt_pk_bf16_f32 v36, v40, v41
    v_exp_f32 v44, v44
    v_exp_f32 v45, v45
    v_cvt_pk_bf16_f32 v37, v42, v43
    v_exp_f32 v46, v46
    v_exp_f32 v47, v47
    v_cvt_pk_bf16_f32 v38, v44, v45
    v_cvt_pk_bf16_f32 v39, v46, v47
    ds_read_b128 v[12:15], v0 offset:2048
    v_exp_f32 v16, v16
    v_exp_f32 v17, v17
    v_mfma_f32_32x32x16_bf16 v[64:79], v[188:191], v[36:39], v[64:79]
    v_exp_f32 v18, v18
    v_exp_f32 v19, v19
    v_cvt_pk_bf16_f32 v16, v16, v17
    v_exp_f32 v20, v20
    v_exp_f32 v21, v21
    v_cvt_pk_bf16_f32 v17, v18, v19
    v_exp_f32 v22, v22
    s_waitcnt vmcnt(12)
    v_mfma_f32_32x32x16_bf16 v[32:47], v[108:111], v[8:11], v[48:63]
    v_permlane16_swap_b32 v192, v196
    v_permlane16_swap_b32 v193, v197
    v_permlane16_swap_b32 v194, v198
    v_permlane16_swap_b32 v195, v199
    v_exp_f32 v23, v23
    v_cvt_pk_bf16_f32 v18, v20, v21
    v_exp_f32 v24, v24
    v_exp_f32 v25, v25
    v_cvt_pk_bf16_f32 v19, v22, v23
    v_exp_f32 v26, v26
    v_exp_f32 v27, v27
    v_mfma_f32_32x32x16_bf16 v[64:79], v[192:195], v[16:19], v[64:79]
    v_cvt_pk_bf16_f32 v20, v24, v25
    v_exp_f32 v28, v28
    v_exp_f32 v29, v29
    v_cvt_pk_bf16_f32 v21, v26, v27
    v_exp_f32 v30, v30
    v_exp_f32 v31, v31
    v_cvt_pk_bf16_f32 v22, v28, v29
    v_cvt_pk_bf16_f32 v23, v30, v31
    v_exp_f32 v32, v32
    v_exp_f32 v33, v33
    v_mfma_f32_32x32x16_bf16 v[64:79], v[196:199], v[20:23], v[64:79]
    v_exp_f32 v34, v34
    v_exp_f32 v35, v35
    v_cvt_pk_bf16_f32 v32, v32, v33
    v_exp_f32 v36, v36
    v_exp_f32 v37, v37
    v_cvt_pk_bf16_f32 v33, v34, v35
    v_exp_f32 v38, v38
    s_waitcnt lgkmcnt(0) vmcnt(11)
    v_mfma_f32_32x32x16_bf16 v[16:31], v[12:15], v[8:11], v[48:63]
    v_permlane16_swap_b32 v200, v204
    v_permlane16_swap_b32 v201, v205
    v_permlane16_swap_b32 v202, v206
    v_permlane16_swap_b32 v203, v207
    v_exp_f32 v39, v39
    v_cvt_pk_bf16_f32 v34, v36, v37
    v_exp_f32 v40, v40
    v_exp_f32 v41, v41
    v_cvt_pk_bf16_f32 v35, v38, v39
    v_exp_f32 v42, v42
    v_exp_f32 v43, v43
    v_mfma_f32_32x32x16_bf16 v[64:79], v[200:203], v[32:35], v[64:79]
    v_cvt_pk_bf16_f32 v36, v40, v41
    v_exp_f32 v44, v44
    v_exp_f32 v45, v45
    v_cvt_pk_bf16_f32 v37, v42, v43
    v_exp_f32 v46, v46
    v_exp_f32 v47, v47
    v_cvt_pk_bf16_f32 v38, v44, v45
    v_cvt_pk_bf16_f32 v39, v46, v47
    v_exp_f32 v16, v16
    v_exp_f32 v17, v17
    v_mfma_f32_32x32x16_bf16 v[64:79], v[204:207], v[36:39], v[64:79]
    v_exp_f32 v18, v18
    v_exp_f32 v19, v19
    v_cvt_pk_bf16_f32 v16, v16, v17
    v_exp_f32 v20, v20
    v_exp_f32 v21, v21
    v_cvt_pk_bf16_f32 v17, v18, v19
    v_exp_f32 v22, v22
    s_waitcnt vmcnt(9)
    v_mfma_f32_32x32x16_bf16 v[32:47], v[112:115], v[8:11], v[48:63]
    v_permlane16_swap_b32 v208, v212
    v_permlane16_swap_b32 v209, v213
    v_permlane16_swap_b32 v210, v214
    v_permlane16_swap_b32 v211, v215
    v_exp_f32 v23, v23
    v_cvt_pk_bf16_f32 v18, v20, v21
    v_exp_f32 v24, v24
    v_exp_f32 v25, v25
    v_cvt_pk_bf16_f32 v19, v22, v23
    v_exp_f32 v26, v26
    v_exp_f32 v27, v27
    v_mfma_f32_32x32x16_bf16 v[64:79], v[208:211], v[16:19], v[64:79]
    v_cvt_pk_bf16_f32 v20, v24, v25
    v_exp_f32 v28, v28
    v_exp_f32 v29, v29
    v_cvt_pk_bf16_f32 v21, v26, v27
    v_exp_f32 v30, v30
    v_exp_f32 v31, v31
    v_cvt_pk_bf16_f32 v22, v28, v29
    v_cvt_pk_bf16_f32 v23, v30, v31
    v_exp_f32 v32, v32
    v_exp_f32 v33, v33
    v_mfma_f32_32x32x16_bf16 v[64:79], v[212:215], v[20:23], v[64:79]
    v_exp_f32 v34, v34
    v_exp_f32 v35, v35
    v_cvt_pk_bf16_f32 v32, v32, v33
    v_exp_f32 v36, v36
    v_exp_f32 v37, v37
    v_cvt_pk_bf16_f32 v33, v34, v35
    v_exp_f32 v38, v38
    s_waitcnt vmcnt(6)
    v_mfma_f32_32x32x16_bf16 v[16:31], v[116:119], v[8:11], v[48:63]
    v_permlane16_swap_b32 v216, v220
    v_permlane16_swap_b32 v217, v221
    v_permlane16_swap_b32 v218, v222
    v_permlane16_swap_b32 v219, v223
    v_exp_f32 v39, v39
    v_cvt_pk_bf16_f32 v34, v36, v37
    v_exp_f32 v40, v40
    v_exp_f32 v41, v41
    v_cvt_pk_bf16_f32 v35, v38, v39
    v_exp_f32 v42, v42
    v_exp_f32 v43, v43
    v_mfma_f32_32x32x16_bf16 v[64:79], v[216:219], v[32:35], v[64:79]
    v_cvt_pk_bf16_f32 v36, v40, v41
    v_exp_f32 v44, v44
    v_exp_f32 v45, v45
    v_cvt_pk_bf16_f32 v37, v42, v43
    v_exp_f32 v46, v46
    v_exp_f32 v47, v47
    v_cvt_pk_bf16_f32 v38, v44, v45
    v_cvt_pk_bf16_f32 v39, v46, v47
    ds_read_b128 v[12:15], v0 offset:3072
    ds_read_b32 v6, v2 offset:2048
    v_exp_f32 v16, v16
    v_exp_f32 v17, v17
    v_mfma_f32_32x32x16_bf16 v[64:79], v[220:223], v[36:39], v[64:79]
    v_exp_f32 v18, v18
    v_exp_f32 v19, v19
    v_cvt_pk_bf16_f32 v16, v16, v17
    v_exp_f32 v20, v20
    v_exp_f32 v21, v21
    v_cvt_pk_bf16_f32 v17, v18, v19
    v_exp_f32 v22, v22
    s_waitcnt vmcnt(4)
    v_mfma_f32_32x32x16_bf16 v[32:47], v[120:123], v[8:11], v[48:63]
    v_permlane16_swap_b32 v224, v228
    v_permlane16_swap_b32 v225, v229
    v_permlane16_swap_b32 v226, v230
    v_permlane16_swap_b32 v227, v231
    v_exp_f32 v23, v23
    v_cvt_pk_bf16_f32 v18, v20, v21
    v_exp_f32 v24, v24
    v_exp_f32 v25, v25
    v_cvt_pk_bf16_f32 v19, v22, v23
    v_exp_f32 v26, v26
    v_exp_f32 v27, v27
    v_mfma_f32_32x32x16_bf16 v[64:79], v[224:227], v[16:19], v[64:79]
    v_cvt_pk_bf16_f32 v20, v24, v25
    v_exp_f32 v28, v28
    v_exp_f32 v29, v29
    v_cvt_pk_bf16_f32 v21, v26, v27
    v_exp_f32 v30, v30
    v_exp_f32 v31, v31
    v_cvt_pk_bf16_f32 v22, v28, v29
    v_cvt_pk_bf16_f32 v23, v30, v31
    v_exp_f32 v32, v32
    v_exp_f32 v33, v33
    v_mfma_f32_32x32x16_bf16 v[64:79], v[228:231], v[20:23], v[64:79]
    v_exp_f32 v34, v34
    v_exp_f32 v35, v35
    v_cvt_pk_bf16_f32 v32, v32, v33
    v_exp_f32 v36, v36
    v_exp_f32 v37, v37
    v_cvt_pk_bf16_f32 v33, v34, v35
    v_exp_f32 v38, v38
    s_waitcnt lgkmcnt(0) vmcnt(3)
    v_mfma_f32_32x32x16_bf16 v[16:31], v[12:15], v[8:11], v[48:63]
    v_cmp_eq_u32 vcc, -1, v6
    v_permlane16_swap_b32 v232, v236
    v_permlane16_swap_b32 v233, v237
    v_permlane16_swap_b32 v234, v238
    v_permlane16_swap_b32 v235, v239
    v_exp_f32 v39, v39
    v_cvt_pk_bf16_f32 v34, v36, v37
    v_exp_f32 v40, v40
    v_exp_f32 v41, v41
    v_cvt_pk_bf16_f32 v35, v38, v39
    v_exp_f32 v42, v42
    v_exp_f32 v43, v43
    v_mfma_f32_32x32x16_bf16 v[64:79], v[232:235], v[32:35], v[64:79]
    v_cvt_pk_bf16_f32 v36, v40, v41
    v_exp_f32 v44, v44
    v_exp_f32 v45, v45
    v_cvt_pk_bf16_f32 v37, v42, v43
    v_exp_f32 v46, v46
    v_exp_f32 v47, v47
    v_cvt_pk_bf16_f32 v38, v44, v45
    v_cvt_pk_bf16_f32 v39, v46, v47
    v_exp_f32 v16, v16
    v_exp_f32 v17, v17
    v_mfma_f32_32x32x16_bf16 v[64:79], v[236:239], v[36:39], v[64:79]
    v_exp_f32 v18, v18
    v_exp_f32 v19, v19
    v_cvt_pk_bf16_f32 v16, v16, v17
    v_exp_f32 v20, v20
    v_exp_f32 v21, v21
    v_cvt_pk_bf16_f32 v17, v18, v19
    v_exp_f32 v22, v22
    s_waitcnt vmcnt(1)
    v_mfma_f32_32x32x16_bf16 v[32:47], v[124:127], v[8:11], v[48:63]
    s_cbranch_vccnz kf_toka
kf_tokreta:
    ds_read_b128 v[8:11], v1 offset:2048
    v_permlane16_swap_b32 v240, v244
    v_permlane16_swap_b32 v241, v245
    v_permlane16_swap_b32 v242, v246
    v_permlane16_swap_b32 v243, v247
    v_exp_f32 v23, v23
    v_cvt_pk_bf16_f32 v18, v20, v21
    v_exp_f32 v24, v24
    v_exp_f32 v25, v25
    v_cvt_pk_bf16_f32 v19, v22, v23
    v_exp_f32 v26, v26
    v_exp_f32 v27, v27
    v_mfma_f32_32x32x16_bf16 v[64:79], v[240:243], v[16:19], v[64:79]
    v_cvt_pk_bf16_f32 v20, v24, v25
    v_exp_f32 v28, v28
    v_exp_f32 v29, v29
    v_cvt_pk_bf16_f32 v21, v26, v27
    v_exp_f32 v30, v30
    v_exp_f32 v31, v31
    v_cvt_pk_bf16_f32 v22, v28, v29
    v_cvt_pk_bf16_f32 v23, v30, v31
    v_mfma_f32_32x32x8_bf16 v[48:63], v[4:5], v[6:7], 0
    v_exp_f32 v32, v32
    v_exp_f32 v33, v33
    v_mfma_f32_32x32x16_bf16 v[64:79], v[244:247], v[20:23], v[64:79]
    v_exp_f32 v34, v34
    v_exp_f32 v35, v35
    v_cvt_pk_bf16_f32 v32, v32, v33
    v_exp_f32 v36, v36
    v_exp_f32 v37, v37
    v_cvt_pk_bf16_f32 v33, v34, v35
    v_exp_f32 v38, v38
    s_waitcnt lgkmcnt(0) vmcnt(0)
    v_mfma_f32_32x32x16_bf16 v[16:31], v[80:83], v[8:11], v[48:63]
    v_permlane16_swap_b32 v248, v252
    v_permlane16_swap_b32 v249, v253
    v_permlane16_swap_b32 v250, v254
    v_permlane16_swap_b32 v251, v255
    v_exp_f32 v39, v39
    v_cvt_pk_bf16_f32 v34, v36, v37
    v_exp_f32 v40, v40
    v_exp_f32 v41, v41
    v_cvt_pk_bf16_f32 v35, v38, v39
    v_exp_f32 v42, v42
    v_exp_f32 v43, v43
    v_mfma_f32_32x32x16_bf16 v[64:79], v[248:251], v[32:35], v[64:79]
    v_cvt_pk_bf16_f32 v36, v40, v41
    v_exp_f32 v44, v44
    v_exp_f32 v45, v45
    v_cvt_pk_bf16_f32 v37, v42, v43
    v_exp_f32 v46, v46
    v_exp_f32 v47, v47
    v_cvt_pk_bf16_f32 v38, v44, v45
    v_cvt_pk_bf16_f32 v39, v46, v47
    v_exp_f32 v16, v16
    v_exp_f32 v17, v17
    v_mfma_f32_32x32x16_bf16 v[64:79], v[252:255], v[36:39], v[64:79]
    v_exp_f32 v18, v18
    v_exp_f32 v19, v19
    v_cvt_pk_bf16_f32 v16, v16, v17
    v_exp_f32 v20, v20
    v_exp_f32 v21, v21
    v_cvt_pk_bf16_f32 v17, v18, v19
    v_exp_f32 v22, v22
    v_mfma_f32_32x32x16_bf16 v[32:47], v[84:87], v[8:11], v[48:63]
    v_exp_f32 v23, v23
    v_cvt_pk_bf16_f32 v18, v20, v21
    v_exp_f32 v24, v24
    v_exp_f32 v25, v25
    v_cvt_pk_bf16_f32 v19, v22, v23
    v_cmp_nle_f32 vcc, v72, s50
    v_exp_f32 v26, v26
    v_exp_f32 v27, v27
    ds_write_b128 v3, v[64:67]
    ds_write_b128 v3, v[68:71] offset:1024
    ds_read_b128 v[12:15], v0 offset:0
    s_cbranch_vccnz kf_ovfa
kf_ovfreta:
    ds_write_b32 v2, v72
    v_xor_b32 v3, s51, v3
    v_add_u32 v1, s52, v1
    v_add_u32 v2, s52, v2
    s_mov_b32 s53, 1
.p2align 6
kf_loop:
    v_mfma_f32_32x32x16_bf16 v[64:79], v[128:131], v[16:19], 0
    v_cvt_pk_bf16_f32 v20, v24, v25
    v_exp_f32 v28, v28
    v_exp_f32 v29, v29
    v_cvt_pk_bf16_f32 v21, v26, v27
    v_exp_f32 v30, v30
    v_exp_f32 v31, v31
    v_cvt_pk_bf16_f32 v22, v28, v29
    v_cvt_pk_bf16_f32 v23, v30, v31
    v_exp_f32 v32, v32
    v_exp_f32 v33, v33
    v_mfma_f32_32x32x16_bf16 v[64:79], v[132:135], v[20:23], v[64:79]
    v_exp_f32 v34, v34
    v_exp_f32 v35, v35
    v_cvt_pk_bf16_f32 v32, v32, v33
    v_exp_f32 v36, v36
    v_exp_f32 v37, v37
    v_cvt_pk_bf16_f32 v33, v34, v35
    v_exp_f32 v38, v38
    s_waitcnt lgkmcnt(0)
    v_mfma_f32_32x32x16_bf16 v[16:31], v[12:15], v[8:11], v[48:63]
    v_exp_f32 v39, v39
    v_cvt_pk_bf16_f32 v34, v36, v37
    v_exp_f32 v40, v40
    v_exp_f32 v41, v41
    v_cvt_pk_bf16_f32 v35, v38, v39
    v_exp_f32 v42, v42
    v_exp_f32 v43, v43
    v_mfma_f32_32x32x16_bf16 v[64:79], v[136:139], v[32:35], v[64:79]
    v_cvt_pk_bf16_f32 v36, v40, v41
    v_exp_f32 v44, v44
    v_exp_f32 v45, v45
    v_cvt_pk_bf16_f32 v37, v42, v43
    v_exp_f32 v46, v46
    v_exp_f32 v47, v47
    v_cvt_pk_bf16_f32 v38, v44, v45
    v_cvt_pk_bf16_f32 v39, v46, v47
    v_exp_f32 v16, v16
    v_exp_f32 v17, v17
    v_mfma_f32_32x32x16_bf16 v[64:79], v[140:143], v[36:39], v[64:79]
    v_exp_f32 v18, v18
    v_exp_f32 v19, v19
    v_cvt_pk_bf16_f32 v16, v16, v17
    v_exp_f32 v20, v20
    v_exp_f32 v21, v21
    v_cvt_pk_bf16_f32 v17, v18, v19
    v_exp_f32 v22, v22
    v_mfma_f32_32x32x16_bf16 v[32:47], v[88:91], v[8:11], v[48:63]
    v_exp_f32 v23, v23
    v_cvt_pk_bf16_f32 v18, v20, v21
    v_exp_f32 v24, v24
    v_exp_f32 v25, v25
    v_cvt_pk_bf16_f32 v19, v22, v23
    v_exp_f32 v26, v26
    v_exp_f32 v27, v27
    v_mfma_f32_32x32x16_bf16 v[64:79], v[144:147], v[16:19], v[64:79]
    v_cvt_pk_bf16_f32 v20, v24, v25
    v_exp_f32 v28, v28
    v_exp_f32 v29, v29
    v_cvt_pk_bf16_f32 v21, v26, v27
    v_exp_f32 v30, v30
    v_exp_f32 v31, v31
    v_cvt_pk_bf16_f32 v22, v28, v29
    v_cvt_pk_bf16_f32 v23, v30, v31
    v_exp_f32 v32, v32
    v_exp_f32 v33, v33
    v_mfma_f32_32x32x16_bf16 v[64:79], v[148:151], v[20:23], v[64:79]
    v_exp_f32 v34, v34
    v_exp_f32 v35, v35
    v_cvt_pk_bf16_f32 v32, v32, v33
    v_exp_f32 v36, v36
    v_exp_f32 v37, v37
    v_cvt_pk_bf16_f32 v33, v34, v35
    v_exp_f32 v38, v38
    v_mfma_f32_32x32x16_bf16 v[16:31], v[92:95], v[8:11], v[48:63]
    v_exp_f32 v39, v39
    v_cvt_pk_bf16_f32 v34, v36, v37
    v_exp_f32 v40, v40
    v_exp_f32 v41, v41
    v_cvt_pk_bf16_f32 v35, v38, v39
    v_exp_f32 v42, v42
    v_exp_f32 v43, v43
    v_mfma_f32_32x32x16_bf16 v[64:79], v[152:155], v[32:35], v[64:79]
    v_cvt_pk_bf16_f32 v36, v40, v41
    v_exp_f32 v44, v44
    v_exp_f32 v45, v45
    v_cvt_pk_bf16_f32 v37, v42, v43
    v_exp_f32 v46, v46
    v_exp_f32 v47, v47
    v_cvt_pk_bf16_f32 v38, v44, v45
    v_cvt_pk_bf16_f32 v39, v46, v47
    ds_read_b128 v[12:15], v0 offset:1024
    v_exp_f32 v16, v16
    v_exp_f32 v17, v17
    v_mfma_f32_32x32x16_bf16 v[64:79], v[156:159], v[36:39], v[64:79]
    v_exp_f32 v18, v18
    v_exp_f32 v19, v19
    v_cvt_pk_bf16_f32 v16, v16, v17
    v_exp_f32 v20, v20
    v_exp_f32 v21, v21
    v_cvt_pk_bf16_f32 v17, v18, v19
    v_exp_f32 v22, v22
    v_mfma_f32_32x32x16_bf16 v[32:47], v[96:99], v[8:11], v[48:63]
    v_exp_f32 v23, v23
    v_cvt_pk_bf16_f32 v18, v20, v21
    v_exp_f32 v24, v24
    v_exp_f32 v25, v25
    v_cvt_pk_bf16_f32 v19, v22, v23
    v_exp_f32 v26, v26
    v_exp_f32 v27, v27
    v_mfma_f32_32x32x16_bf16 v[64:79], v[160:163], v[16:19], v[64:79]
    v_cvt_pk_bf16_f32 v20, v24, v25
    v_exp_f32 v28, v28
    v_exp_f32 v29, v29
    v_cvt_pk_bf16_f32 v21, v26, v27
    v_exp_f32 v30, v30
    v_exp_f32 v31, v31
    v_cvt_pk_bf16_f32 v22, v28, v29
    v_cvt_pk_bf16_f32 v23, v30, v31
    v_exp_f32 v32, v32
    v_exp_f32 v33, v33
    v_mfma_f32_32x32x16_bf16 v[64:79], v[164:167], v[20:23], v[64:79]
    v_exp_f32 v34, v34
    v_exp_f32 v35, v35
    v_cvt_pk_bf16_f32 v32, v32, v33
    v_exp_f32 v36, v36
    v_exp_f32 v37, v37
    v_cvt_pk_bf16_f32 v33, v34, v35
    v_exp_f32 v38, v38
    s_waitcnt lgkmcnt(0)
    v_mfma_f32_32x32x16_bf16 v[16:31], v[12:15], v[8:11], v[48:63]
    v_exp_f32 v39, v39
    v_cvt_pk_bf16_f32 v34, v36, v37
    v_exp_f32 v40, v40
    v_exp_f32 v41, v41
    v_cvt_pk_bf16_f32 v35, v38, v39
    v_exp_f32 v42, v42
    v_exp_f32 v43, v43
    v_mfma_f32_32x32x16_bf16 v[64:79], v[168:171], v[32:35], v[64:79]
    v_cvt_pk_bf16_f32 v36, v40, v41
    v_exp_f32 v44, v44
    v_exp_f32 v45, v45
    v_cvt_pk_bf16_f32 v37, v42, v43
    v_exp_f32 v46, v46
    v_exp_f32 v47, v47
    v_cvt_pk_bf16_f32 v38, v44, v45
    v_cvt_pk_bf16_f32 v39, v46, v47
    v_exp_f32 v16, v16
    v_exp_f32 v17, v17
    v_mfma_f32_32x32x16_bf16 v[64:79], v[172:175], v[36:39], v[64:79]
    v_exp_f32 v18, v18
    v_exp_f32 v19, v19
    v_cvt_pk_bf16_f32 v16, v16, v17
    v_exp_f32 v20, v20
    v_exp_f32 v21, v21
    v_cvt_pk_bf16_f32 v17, v18, v19
    v_exp_f32 v22, v22
    v_mfma_f32_32x32x16_bf16 v[32:47], v[100:103], v[8:11], v[48:63]
    v_exp_f32 v23, v23
    v_cvt_pk_bf16_f32 v18, v20, v21
    v_exp_f32 v24, v24
    v_exp_f32 v25, v25
    v_cvt_pk_bf16_f32 v19, v22, v23
    v_exp_f32 v26, v26
    v_exp_f32 v27, v27
    v_mfma_f32_32x32x16_bf16 v[64:79], v[176:179], v[16:19], v[64:79]
    v_cvt_pk_bf16_f32 v20, v24, v25
    v_exp_f32 v28, v28
    v_exp_f32 v29, v29
    v_cvt_pk_bf16_f32 v21, v26, v27
    v_exp_f32 v30, v30
    v_exp_f32 v31, v31
    v_cvt_pk_bf16_f32 v22, v28, v29
    v_cvt_pk_bf16_f32 v23, v30, v31
    v_exp_f32 v32, v32
    v_exp_f32 v33, v33
    v_mfma_f32_32x32x16_bf16 v[64:79], v[180:183], v[20:23], v[64:79]
    v_exp_f32 v34, v34
    v_exp_f32 v35, v35
    v_cvt_pk_bf16_f32 v32, v32, v33
    v_exp_f32 v36, v36
    v_exp_f32 v37, v37
    v_cvt_pk_bf16_f32 v33, v34, v35
    v_exp_f32 v38, v38
    v_mfma_f32_32x32x16_bf16 v[16:31], v[104:107], v[8:11], v[48:63]
    v_exp_f32 v39, v39
    v_cvt_pk_bf16_f32 v34, v36, v37
    v_exp_f32 v40, v40
    v_exp_f32 v41, v41
    v_cvt_pk_bf16_f32 v35, v38, v39
    v_exp_f32 v42, v42
    v_exp_f32 v43, v43
    v_mfma_f32_32x32x16_bf16 v[64:79], v[184:187], v[32:35], v[64:79]
    v_cvt_pk_bf16_f32 v36, v40, v41
    v_exp_f32 v44, v44
    v_exp_f32 v45, v45
    v_cvt_pk_bf16_f32 v37, v42, v43
    v_exp_f32 v46, v46
    v_exp_f32 v47, v47
    v_cvt_pk_bf16_f32 v38, v44, v45
    v_cvt_pk_bf16_f32 v39, v46, v47
    ds_read_b128 v[12:15], v0 offset:2048
    v_exp_f32 v16, v16
    v_exp_f32 v17, v17
    v_mfma_f32_32x32x16_bf16 v[64:79], v[188:191], v[36:39], v[64:79]
    v_exp_f32 v18, v18
    v_exp_f32 v19, v19
    v_cvt_pk_bf16_f32 v16, v16, v17
    v_exp_f32 v20, v20
    v_exp_f32 v21, v21
    v_cvt_pk_bf16_f32 v17, v18, v19
    v_exp_f32 v22, v22
    v_mfma_f32_32x32x16_bf16 v[32:47], v[108:111], v[8:11], v[48:63]
    v_exp_f32 v23, v23
    v_cvt_pk_bf16_f32 v18, v20, v21
    v_exp_f32 v24, v24
    v_exp_f32 v25, v25
    v_cvt_pk_bf16_f32 v19, v22, v23
    v_exp_f32 v26, v26
    v_exp_f32 v27, v27
    v_mfma_f32_32x32x16_bf16 v[64:79], v[192:195], v[16:19], v[64:79]
    v_cvt_pk_bf16_f32 v20, v24, v25
    v_exp_f32 v28, v28
    v_exp_f32 v29, v29
    v_cvt_pk_bf16_f32 v21, v26, v27
    v_exp_f32 v30, v30
    v_exp_f32 v31, v31
    v_cvt_pk_bf16_f32 v22, v28, v29
    v_cvt_pk_bf16_f32 v23, v30, v31
    v_exp_f32 v32, v32
    v_exp_f32 v33, v33
    v_mfma_f32_32x32x16_bf16 v[64:79], v[196:199], v[20:23], v[64:79]
    v_exp_f32 v34, v34
    v_exp_f32 v35, v35
    v_cvt_pk_bf16_f32 v32, v32, v33
    v_exp_f32 v36, v36
    v_exp_f32 v37, v37
    v_cvt_pk_bf16_f32 v33, v34, v35
    v_exp_f32 v38, v38
    s_waitcnt lgkmcnt(0)
    v_mfma_f32_32x32x16_bf16 v[16:31], v[12:15], v[8:11], v[48:63]
    v_exp_f32 v39, v39
    v_cvt_pk_bf16_f32 v34, v36, v37
    v_exp_f32 v40, v40
    v_exp_f32 v41, v41
    v_cvt_pk_bf16_f32 v35, v38, v39
    v_exp_f32 v42, v42
    v_exp_f32 v43, v43
    v_mfma_f32_32x32x16_bf16 v[64:79], v[200:203], v[32:35], v[64:79]
    v_cvt_pk_bf16_f32 v36, v40, v41
    v_exp_f32 v44, v44
    v_exp_f32 v45, v45
    v_cvt_pk_bf16_f32 v37, v42, v43
    v_exp_f32 v46, v46
    v_exp_f32 v47, v47
    v_cvt_pk_bf16_f32 v38, v44, v45
    v_cvt_pk_bf16_f32 v39, v46, v47
    v_exp_f32 v16, v16
    v_exp_f32 v17, v17
    v_mfma_f32_32x32x16_bf16 v[64:79], v[204:207], v[36:39], v[64:79]
    v_exp_f32 v18, v18
    v_exp_f32 v19, v19
    v_cvt_pk_bf16_f32 v16, v16, v17
    v_exp_f32 v20, v20
    v_exp_f32 v21, v21
    v_cvt_pk_bf16_f32 v17, v18, v19
    v_exp_f32 v22, v22
    v_mfma_f32_32x32x16_bf16 v[32:47], v[112:115], v[8:11], v[48:63]
    v_exp_f32 v23, v23
    v_cvt_pk_bf16_f32 v18, v20, v21
    v_exp_f32 v24, v24
    v_exp_f32 v25, v25
    v_cvt_pk_bf16_f32 v19, v22, v23
    v_exp_f32 v26, v26
    v_exp_f32 v27, v27
    v_mfma_f32_32x32x16_bf16 v[64:79], v[208:211], v[16:19], v[64:79]
    v_cvt_pk_bf16_f32 v20, v24, v25
    v_exp_f32 v28, v28
    v_exp_f32 v29, v29
    v_cvt_pk_bf16_f32 v21, v26, v27
    v_exp_f32 v30, v30
    v_exp_f32 v31, v31
    v_cvt_pk_bf16_f32 v22, v28, v29
    v_cvt_pk_bf16_f32 v23, v30, v31
    v_exp_f32 v32, v32
    v_exp_f32 v33, v33
    v_mfma_f32_32x32x16_bf16 v[64:79], v[212:215], v[20:23], v[64:79]
    v_exp_f32 v34, v34
    v_exp_f32 v35, v35
    v_cvt_pk_bf16_f32 v32, v32, v33
    v_exp_f32 v36, v36
    v_exp_f32 v37, v37
    v_cvt_pk_bf16_f32 v33, v34, v35
    v_exp_f32 v38, v38
    v_mfma_f32_32x32x16_bf16 v[16:31], v[116:119], v[8:11], v[48:63]
    v_exp_f32 v39, v39
    v_cvt_pk_bf16_f32 v34, v36, v37
    v_exp_f32 v40, v40
    v_exp_f32 v41, v41
    v_cvt_pk_bf16_f32 v35, v38, v39
    v_exp_f32 v42, v42
    v_exp_f32 v43, v43
    v_mfma_f32_32x32x16_bf16 v[64:79], v[216:219], v[32:35], v[64:79]
    v_cvt_pk_bf16_f32 v36, v40, v41
    v_exp_f32 v44, v44
    v_exp_f32 v45, v45
    v_cvt_pk_bf16_f32 v37, v42, v43
    v_exp_f32 v46, v46
    v_exp_f32 v47, v47
    v_cvt_pk_bf16_f32 v38, v44, v45
    v_cvt_pk_bf16_f32 v39, v46, v47
    ds_read_b128 v[12:15], v0 offset:3072
    ds_read_b32 v6, v2 offset:2048
    v_exp_f32 v16, v16
    v_exp_f32 v17, v17
    v_mfma_f32_32x32x16_bf16 v[64:79], v[220:223], v[36:39], v[64:79]
    v_exp_f32 v18, v18
    v_exp_f32 v19, v19
    v_cvt_pk_bf16_f32 v16, v16, v17
    v_exp_f32 v20, v20
    v_exp_f32 v21, v21
    v_cvt_pk_bf16_f32 v17, v18, v19
    v_exp_f32 v22, v22
    v_mfma_f32_32x32x16_bf16 v[32:47], v[120:123], v[8:11], v[48:63]
    v_exp_f32 v23, v23
    v_cvt_pk_bf16_f32 v18, v20, v21
    v_exp_f32 v24, v24
    v_exp_f32 v25, v25
    v_cvt_pk_bf16_f32 v19, v22, v23
    v_exp_f32 v26, v26
    v_exp_f32 v27, v27
    v_mfma_f32_32x32x16_bf16 v[64:79], v[224:227], v[16:19], v[64:79]
    v_cvt_pk_bf16_f32 v20, v24, v25
    v_exp_f32 v28, v28
    v_exp_f32 v29, v29
    v_cvt_pk_bf16_f32 v21, v26, v27
    v_exp_f32 v30, v30
    v_exp_f32 v31, v31
    v_cvt_pk_bf16_f32 v22, v28, v29
    v_cvt_pk_bf16_f32 v23, v30, v31
    v_exp_f32 v32, v32
    v_exp_f32 v33, v33
    v_mfma_f32_32x32x16_bf16 v[64:79], v[228:231], v[20:23], v[64:79]
    v_exp_f32 v34, v34
    v_exp_f32 v35, v35
    v_cvt_pk_bf16_f32 v32, v32, v33
    v_exp_f32 v36, v36
    v_exp_f32 v37, v37
    v_cvt_pk_bf16_f32 v33, v34, v35
    v_exp_f32 v38, v38
    s_waitcnt lgkmcnt(0)
    v_mfma_f32_32x32x16_bf16 v[16:31], v[12:15], v[8:11], v[48:63]
    v_cmp_eq_u32 vcc, -1, v6
    v_exp_f32 v39, v39
    v_cvt_pk_bf16_f32 v34, v36, v37
    v_exp_f32 v40, v40
    v_exp_f32 v41, v41
    v_cvt_pk_bf16_f32 v35, v38, v39
    v_exp_f32 v42, v42
    v_exp_f32 v43, v43
    v_mfma_f32_32x32x16_bf16 v[64:79], v[232:235], v[32:35], v[64:79]
    v_cvt_pk_bf16_f32 v36, v40, v41
    v_exp_f32 v44, v44
    v_exp_f32 v45, v45
    v_cvt_pk_bf16_f32 v37, v42, v43
    v_exp_f32 v46, v46
    v_exp_f32 v47, v47
    v_cvt_pk_bf16_f32 v38, v44, v45
    v_cvt_pk_bf16_f32 v39, v46, v47
    v_exp_f32 v16, v16
    v_exp_f32 v17, v17
    v_mfma_f32_32x32x16_bf16 v[64:79], v[236:239], v[36:39], v[64:79]
    v_exp_f32 v18, v18
    v_exp_f32 v19, v19
    v_cvt_pk_bf16_f32 v16, v16, v17
    v_exp_f32 v20, v20
    v_exp_f32 v21, v21
    v_cvt_pk_bf16_f32 v17, v18, v19
    v_exp_f32 v22, v22
    v_mfma_f32_32x32x16_bf16 v[32:47], v[124:127], v[8:11], v[48:63]
    s_cbranch_vccnz kf_tokb
kf_tokretb:
    ds_read_b128 v[8:11], v1 offset:2048
    v_exp_f32 v23, v23
    v_cvt_pk_bf16_f32 v18, v20, v21
    v_exp_f32 v24, v24
    v_exp_f32 v25, v25
    v_cvt_pk_bf16_f32 v19, v22, v23
    v_exp_f32 v26, v26
    v_exp_f32 v27, v27
    v_mfma_f32_32x32x16_bf16 v[64:79], v[240:243], v[16:19], v[64:79]
    v_cvt_pk_bf16_f32 v20, v24, v25
    v_exp_f32 v28, v28
    v_exp_f32 v29, v29
    v_cvt_pk_bf16_f32 v21, v26, v27
    v_exp_f32 v30, v30
    v_exp_f32 v31, v31
    v_cvt_pk_bf16_f32 v22, v28, v29
    v_cvt_pk_bf16_f32 v23, v30, v31
    v_mfma_f32_32x32x8_bf16 v[48:63], v[4:5], v[6:7], 0
    v_exp_f32 v32, v32
    v_exp_f32 v33, v33
    v_mfma_f32_32x32x16_bf16 v[64:79], v[244:247], v[20:23], v[64:79]
    v_exp_f32 v34, v34
    v_exp_f32 v35, v35
    v_cvt_pk_bf16_f32 v32, v32, v33
    v_exp_f32 v36, v36
    v_exp_f32 v37, v37
    v_cvt_pk_bf16_f32 v33, v34, v35
    v_exp_f32 v38, v38
    s_waitcnt lgkmcnt(0)
    v_mfma_f32_32x32x16_bf16 v[16:31], v[80:83], v[8:11], v[48:63]
    v_exp_f32 v39, v39
    v_cvt_pk_bf16_f32 v34, v36, v37
    v_exp_f32 v40, v40
    v_exp_f32 v41, v41
    v_cvt_pk_bf16_f32 v35, v38, v39
    v_exp_f32 v42, v42
    v_exp_f32 v43, v43
    v_mfma_f32_32x32x16_bf16 v[64:79], v[248:251], v[32:35], v[64:79]
    v_cvt_pk_bf16_f32 v36, v40, v41
    v_exp_f32 v44, v44
    v_exp_f32 v45, v45
    v_cvt_pk_bf16_f32 v37, v42, v43
    v_exp_f32 v46, v46
    v_exp_f32 v47, v47
    v_cvt_pk_bf16_f32 v38, v44, v45
    v_cvt_pk_bf16_f32 v39, v46, v47
    v_exp_f32 v16, v16
    v_exp_f32 v17, v17
    v_mfma_f32_32x32x16_bf16 v[64:79], v[252:255], v[36:39], v[64:79]
    v_exp_f32 v18, v18
    v_exp_f32 v19, v19
    v_cvt_pk_bf16_f32 v16, v16, v17
    v_exp_f32 v20, v20
    v_exp_f32 v21, v21
    v_cvt_pk_bf16_f32 v17, v18, v19
    v_exp_f32 v22, v22
    v_mfma_f32_32x32x16_bf16 v[32:47], v[84:87], v[8:11], v[48:63]
    v_exp_f32 v23, v23
    v_cvt_pk_bf16_f32 v18, v20, v21
    v_exp_f32 v24, v24
    v_exp_f32 v25, v25
    v_cvt_pk_bf16_f32 v19, v22, v23
    v_cmp_nle_f32 vcc, v72, s50
    v_exp_f32 v26, v26
    v_exp_f32 v27, v27
    ds_write_b128 v3, v[64:67]
    ds_write_b128 v3, v[68:71] offset:1024
    ds_read_b128 v[12:15], v0 offset:0
    s_cbranch_vccnz kf_ovfb
kf_ovfretb:
    ds_write_b32 v2, v72
    v_xor_b32 v3, s51, v3
    v_add_u32 v1, s52, v1
    v_add_u32 v2, s52, v2
    s_add_u32 s53, s53, 1
    s_cmp_lt_u32 s53, 8
    s_cbranch_scc1 kf_loop
    v_mov_b32 v8, 100408
    v_mov_b32 v9, 1
    s_mov_b64 exec, 1
    ds_add_rtn_u32 v9, v8, v9
    s_mov_b64 exec, -1
    v_subrev_u32 v1, s45, v0
    v_add_u32 v64, 97280, v1
    v_add_u32 v65, 73728, v1
    v_bfe_u32 v66, v1, 2, 7
    v_add_u32 v66, 99200, v66
    v_mov_b32 v67, 100380
    s_mov_b32 s62, 7
    s_lshl_b32 s63, s38, 16
    s_lshl_b32 s40, s39, 12
    s_add_u32 s63, s63, s40
    s_add_u32 s63, s63, 4718592
    s_waitcnt lgkmcnt(0)
    v_readfirstlane_b32 s40, v9
    s_nop 0
    s_cmp_eq_u32 s40, 3
    s_cbranch_scc0 1f
    s_call_b64 s[60:61], kf_merge7
1:
    s_endpgm
kf_toka:
    s_cmp_eq_u32 s53, 7
    s_cbranch_scc1 kf_tokreta
    ds_read_b32 v6, v2 offset:2048
    s_waitcnt lgkmcnt(0)
    v_cmp_eq_u32 vcc, -1, v6
    s_nop 0
    s_cbranch_vccz kf_tokreta
    s_sleep 1
    s_branch kf_toka
kf_ovfa:
    s_cmp_lg_u32 s49, s53
    s_cbranch_scc1 kf_redo
    v_and_b32 v72, 0x7fffffff, v72
    s_branch kf_ovfreta
kf_tokb:
    s_cmp_eq_u32 s53, 7
    s_cbranch_scc1 kf_tokretb
    ds_read_b32 v6, v2 offset:2048
    s_waitcnt lgkmcnt(0)
    v_cmp_eq_u32 vcc, -1, v6
    s_nop 0
    s_cbranch_vccz kf_tokretb
    s_sleep 1
    s_branch kf_tokb
kf_ovfb:
    s_cmp_lg_u32 s49, s53
    s_cbranch_scc1 kf_redo
    v_and_b32 v72, 0x7fffffff, v72
    s_branch kf_ovfretb
kf_redo:
    s_mov_b32 s49, s53
    s_waitcnt lgkmcnt(0)
    ds_read_b128 v[8:11], v1
    v_mov_b32 v64, 0xff800000
    s_nop 15
    s_waitcnt lgkmcnt(0)
    v_mfma_f32_32x32x16_bf16 v[16:31], v[80:83], v[8:11], 0
    s_nop 11
    v_max3_f32 v64, v16, v17, v64
    v_max3_f32 v64, v18, v19, v64
    v_max3_f32 v64, v20, v21, v64
    v_max3_f32 v64, v22, v23, v64
    v_max3_f32 v64, v24, v25, v64
    v_max3_f32 v64, v26, v27, v64
    v_max3_f32 v64, v28, v29, v64
    v_max3_f32 v64, v30, v31, v64
    s_waitcnt lgkmcnt(0)
    v_mfma_f32_32x32x16_bf16 v[16:31], v[84:87], v[8:11], 0
    s_nop 11
    v_max3_f32 v64, v16, v17, v64
    v_max3_f32 v64, v18, v19, v64
    v_max3_f32 v64, v20, v21, v64
    v_max3_f32 v64, v22, v23, v64
    v_max3_f32 v64, v24, v25, v64
    v_max3_f32 v64, v26, v27, v64
    v_max3_f32 v64, v28, v29, v64
    v_max3_f32 v64, v30, v31, v64
    ds_read_b128 v[12:15], v0 offset:0
    s_waitcnt lgkmcnt(0)
    v_mfma_f32_32x32x16_bf16 v[16:31], v[12:15], v[8:11], 0
    s_nop 11
    v_max3_f32 v64, v16, v17, v64
    v_max3_f32 v64, v18, v19, v64
    v_max3_f32 v64, v20, v21, v64
    v_max3_f32 v64, v22, v23, v64
    v_max3_f32 v64, v24, v25, v64
    v_max3_f32 v64, v26, v27, v64
    v_max3_f32 v64, v28, v29, v64
    v_max3_f32 v64, v30, v31, v64
    s_waitcnt lgkmcnt(0)
    v_mfma_f32_32x32x16_bf16 v[16:31], v[88:91], v[8:11], 0
    s_nop 11
    v_max3_f32 v64, v16, v17, v64
    v_max3_f32 v64, v18, v19, v64
    v_max3_f32 v64, v20, v21, v64
    v_max3_f32 v64, v22, v23, v64
    v_max3_f32 v64, v24, v25, v64
    v_max3_f32 v64, v26, v27, v64
    v_max3_f32 v64, v28, v29, v64
    v_max3_f32 v64, v30, v31, v64
    s_waitcnt lgkmcnt(0)
    v_mfma_f32_32x32x16_bf16 v[16:31], v[92:95], v[8:11], 0
    s_nop 11
    v_max3_f32 v64, v16, v17, v64
    v_max3_f32 v64, v18, v19, v64
    v_max3_f32 v64, v20, v21, v64
    v_max3_f32 v64, v22, v23, v64
    v_max3_f32 v64, v24, v25, v64
    v_max3_f32 v64, v26, v27, v64
    v_max3_f32 v64, v28, v29, v64
    v_max3_f32 v64, v30, v31, v64
    s_waitcnt lgkmcnt(0)
    v_mfma_f32_32x32x16_bf16 v[16:31], v[96:99], v[8:11], 0
    s_nop 11
    v_max3_f32 v64, v16, v17, v64
    v_max3_f32 v64, v18, v19, v64
    v_max3_f32 v64, v20, v21, v64
    v_max3_f32 v64, v22, v23, v64
    v_max3_f32 v64, v24, v25, v64
    v_max3_f32 v64, v26, v27, v64
    v_max3_f32 v64, v28, v29, v64
    v_max3_f32 v64, v30, v31, v64
    ds_read_b128 v[12:15], v0 offset:1024
    s_waitcnt lgkmcnt(0)
    v_mfma_f32_32x32x16_bf16 v[16:31], v[12:15], v[8:11], 0
    s_nop 11
    v_max3_f32 v64, v16, v17, v64
    v_max3_f32 v64, v18, v19, v64
    v_max3_f32 v64, v20, v21, v64
    v_max3_f32 v64, v22, v23, v64
    v_max3_f32 v64, v24, v25, v64
    v_max3_f32 v64, v26, v27, v64
    v_max3_f32 v64, v28, v29, v64
    v_max3_f32 v64, v30, v31, v64
    s_waitcnt lgkmcnt(0)
    v_mfma_f32_32x32x16_bf16 v[16:31], v[100:103], v[8:11], 0
    s_nop 11
    v_max3_f32 v64, v16, v17, v64
    v_max3_f32 v64, v18, v19, v64
    v_max3_f32 v64, v20, v21, v64
    v_max3_f32 v64, v22, v23, v64
    v_max3_f32 v64, v24, v25, v64
    v_max3_f32 v64, v26, v27, v64
    v_max3_f32 v64, v28, v29, v64
    v_max3_f32 v64, v30, v31, v64
    s_waitcnt lgkmcnt(0)
    v_mfma_f32_32x32x16_bf16 v[16:31], v[104:107], v[8:11], 0
    s_nop 11
    v_max3_f32 v64, v16, v17, v64
    v_max3_f32 v64, v18, v19, v64
    v_max3_f32 v64, v20, v21, v64
    v_max3_f32 v64, v22, v23, v64
    v_max3_f32 v64, v24, v25, v64
    v_max3_f32 v64, v26, v27, v64
    v_max3_f32 v64, v28, v29, v64
    v_max3_f32 v64, v30, v31, v64
    s_waitcnt lgkmcnt(0)
    v_mfma_f32_32x32x16_bf16 v[16:31], v[108:111], v[8:11], 0
    s_nop 11
    v_max3_f32 v64, v16, v17, v64
    v_max3_f32 v64, v18, v19, v64
    v_max3_f32 v64, v20, v21, v64
    v_max3_f32 v64, v22, v23, v64
    v_max3_f32 v64, v24, v25, v64
    v_max3_f32 v64, v26, v27, v64
    v_max3_f32 v64, v28, v29, v64
    v_max3_f32 v64, v30, v31, v64
    ds_read_b128 v[12:15], v0 offset:2048
    s_waitcnt lgkmcnt(0)
    v_mfma_f32_32x32x16_bf16 v[16:31], v[12:15], v[8:11], 0
    s_nop 11
    v_max3_f32 v64, v16, v17, v64
    v_max3_f32 v64, v18, v19, v64
    v_max3_f32 v64, v20, v21, v64
    v_max3_f32 v64, v22, v23, v64
    v_max3_f32 v64, v24, v25, v64
    v_max3_f32 v64, v26, v27, v64
    v_max3_f32 v64, v28, v29, v64
    v_max3_f32 v64, v30, v31, v64
    s_waitcnt lgkmcnt(0)
    v_mfma_f32_32x32x16_bf16 v[16:31], v[112:115], v[8:11], 0
    s_nop 11
    v_max3_f32 v64, v16, v17, v64
    v_max3_f32 v64, v18, v19, v64
    v_max3_f32 v64, v20, v21, v64
    v_max3_f32 v64, v22, v23, v64
    v_max3_f32 v64, v24, v25, v64
    v_max3_f32 v64, v26, v27, v64
    v_max3_f32 v64, v28, v29, v64
    v_max3_f32 v64, v30, v31, v64
    s_waitcnt lgkmcnt(0)
    v_mfma_f32_32x32x16_bf16 v[16:31], v[116:119], v[8:11], 0
    s_nop 11
    v_max3_f32 v64, v16, v17, v64
    v_max3_f32 v64, v18, v19, v64
    v_max3_f32 v64, v20, v21, v64
    v_max3_f32 v64, v22, v23, v64
    v_max3_f32 v64, v24, v25, v64
    v_max3_f32 v64, v26, v27, v64
    v_max3_f32 v64, v28, v29, v64
    v_max3_f32 v64, v30, v31, v64
    s_waitcnt lgkmcnt(0)
    v_mfma_f32_32x32x16_bf16 v[16:31], v[120:123], v[8:11], 0
    s_nop 11
    v_max3_f32 v64, v16, v17, v64
    v_max3_f32 v64, v18, v19, v64
    v_max3_f32 v64, v20, v21, v64
    v_max3_f32 v64, v22, v23, v64
    v_max3_f32 v64, v24, v25, v64
    v_max3_f32 v64, v26, v27, v64
    v_max3_f32 v64, v28, v29, v64
    v_max3_f32 v64, v30, v31, v64
    ds_read_b128 v[12:15], v0 offset:3072
    s_waitcnt lgkmcnt(0)
    v_mfma_f32_32x32x16_bf16 v[16:31], v[12:15], v[8:11], 0
    s_nop 11
    v_max3_f32 v64, v16, v17, v64
    v_max3_f32 v64, v18, v19, v64
    v_max3_f32 v64, v20, v21, v64
    v_max3_f32 v64, v22, v23, v64
    v_max3_f32 v64, v24, v25, v64
    v_max3_f32 v64, v26, v27, v64
    v_max3_f32 v64, v28, v29, v64
    v_max3_f32 v64, v30, v31, v64
    s_waitcnt lgkmcnt(0)
    v_mfma_f32_32x32x16_bf16 v[16:31], v[124:127], v[8:11], 0
    s_nop 11
    v_max3_f32 v64, v16, v17, v64
    v_max3_f32 v64, v18, v19, v64
    v_max3_f32 v64, v20, v21, v64
    v_max3_f32 v64, v22, v23, v64
    v_max3_f32 v64, v24, v25, v64
    v_max3_f32 v64, v26, v27, v64
    v_max3_f32 v64, v28, v29, v64
    v_max3_f32 v64, v30, v31, v64
    v_mov_b32 v65, v64
    s_nop 1
    v_permlane32_swap_b32 v64, v65
    v_max_f32 v64, v64, v65
    v_sub_f32 v64, 0, v64
    v_mov_b32 v48, v64
    v_mov_b32 v49, v64
    v_mov_b32 v50, v64
    v_mov_b32 v51, v64
    v_mov_b32 v52, v64
    v_mov_b32 v53, v64
    v_mov_b32 v54, v64
    v_mov_b32 v55, v64
    v_mov_b32 v56, v64
    v_mov_b32 v57, v64
    v_mov_b32 v58, v64
    v_mov_b32 v59, v64
    v_mov_b32 v60, v64
    v_mov_b32 v61, v64
    v_mov_b32 v62, v64
    v_mov_b32 v63, v64
    v_mbcnt_lo_u32_b32 v65, -1, 0
    v_and_b32 v65, 31, v65
    s_and_b32 s40, s53, 1
    s_lshl_b32 s40, s40, 2
    s_add_u32 s40, s40, s32
    s_lshl_b32 s40, s40, 7
    s_add_u32 s40, s40, 99328
    v_lshl_add_u32 v65, v65, 2, s40
    s_mov_b32 exec_hi, 0
    ds_write_b32 v65, v64
    s_lshl_b32 s40, s53, 2
    s_add_u32 s40, s40, 100352
    s_lshl_b32 s41, 1, s32
    v_mov_b32 v66, s40
    v_mov_b32 v67, s41
    s_mov_b64 exec, 1
    ds_or_b32 v66, v67
    s_mov_b64 exec, -1
    v_mfma_f32_32x32x16_bf16 v[16:31], v[80:83], v[8:11], v[48:63]
    s_nop 11
    v_exp_f32 v16, v16
    v_exp_f32 v17, v17
    v_exp_f32 v18, v18
    v_exp_f32 v19, v19
    v_cvt_pk_bf16_f32 v16, v16, v17
    v_exp_f32 v20, v20
    v_exp_f32 v21, v21
    v_cvt_pk_bf16_f32 v17, v18, v19
    v_exp_f32 v22, v22
    v_mfma_f32_32x32x16_bf16 v[32:47], v[84:87], v[8:11], v[48:63]
    v_exp_f32 v23, v23
    v_cvt_pk_bf16_f32 v18, v20, v21
    v_exp_f32 v24, v24
    v_exp_f32 v25, v25
    v_cvt_pk_bf16_f32 v19, v22, v23
    v_exp_f32 v26, v26
    v_exp_f32 v27, v27
    ds_read_b128 v[12:15], v0 offset:0
    s_branch kf_loop
kf_pubkv:
7:
    v_readfirstlane_b32 s74, v108
    v_readfirstlane_b32 s75, v109
    s_cmp_lg_u32 s74, 0
    s_cbranch_scc1 8f
    s_sleep 2
    buffer_load_dwordx2 v[108:109], v110, s[24:27], 0 offen sc1
    s_waitcnt vmcnt(0)
    s_branch 7b
8:
    s_lshl_b32 s49, s38, 7
    s_lshl_b32 s41, s39, 3
    s_add_u32 s49, s49, s41
    s_add_u32 s49, s49, 4456448
    v_lshlrev_b32 v111, 12, v2
    s_mov_b64 exec, 255
    buffer_store_dwordx2 v[108:109], v111, s[28:31], s49 offen sc1
    s_mov_b64 exec, -1
    s_setpc_b64 s[60:61]
kf_ffn:
    s_lshr_b32 s42, s35, 1
    s_and_b32 s43, s35, 1
    s_lshl_b32 s44, s39, 7
    s_lshl_b32 s45, s42, 6
    s_add_u32 s44, s44, s45
    s_lshl_b32 s45, s43, 18
    s_add_u32 s44, s44, s45
    s_lshl_b32 s45, s35, 12
    s_add_u32 s45, s45, 65536
    v_lshrrev_b32 v57, 2, v2
    v_lshlrev_b32 v57, 10, v57
    v_lshl_add_u32 v57, v48, 4, v57
    s_mul_i32 s47, s35, 11264
    s_add_u32 s47, s47, 118784
    s_lshl_b32 s52, s42, 2
    s_add_u32 s52, s52, s43
    s_lshl_b32 s49, s52, 11
    s_add_u32 s49, s49, 81920
    v_lshlrev_b32 v106, 6, v50
    v_lshl_add_u32 v106, v49, 5, v106
    v_lshl_add_u32 v106, v48, 3, v106
    v_add_u32 v107, s47, v106
    v_add_u32 v108, s49, v106
    v_add_u32 v106, s45, v106
    v_add_u32 v51, s45, v56
    s_lshl_b32 s40, s43, 15
    s_lshl_b32 s41, s43, 14
    s_add_u32 s40, s40, s41
    v_add_u32 v116, s40, v52
    v_xor_b32 v120, 0x8000, v116
    v_add_u32 v117, s40, v53
    v_xor_b32 v121, 0x8000, v117
    v_add_u32 v118, s40, v54
    v_xor_b32 v122, 0x8000, v118
    v_add_u32 v119, s40, v55
    v_xor_b32 v123, 0x8000, v119
    v_mov_b32 v40, 0
    v_mov_b32 v41, 0
    v_mov_b32 v42, 0
    v_mov_b32 v43, 0
    s_waitcnt vmcnt(7)
    v_dot2c_f32_bf16 v40, v8, v44
    v_dot2c_f32_bf16 v42, v8, v8
    v_dot2c_f32_bf16 v41, v9, v44
    v_dot2c_f32_bf16 v43, v9, v9
    v_dot2c_f32_bf16 v40, v10, v44
    v_dot2c_f32_bf16 v42, v10, v10
    v_dot2c_f32_bf16 v41, v11, v44
    v_dot2c_f32_bf16 v43, v11, v11
    s_waitcnt vmcnt(6)
    v_dot2c_f32_bf16 v40, v12, v44
    v_dot2c_f32_bf16 v42, v12, v12
    v_dot2c_f32_bf16 v41, v13, v44
    v_dot2c_f32_bf16 v43, v13, v13
    v_dot2c_f32_bf16 v40, v14, v44
    v_dot2c_f32_bf16 v42, v14, v14
    v_dot2c_f32_bf16 v41, v15, v44
    v_dot2c_f32_bf16 v43, v15, v15
    s_waitcnt vmcnt(5)
    v_dot2c_f32_bf16 v40, v16, v44
    v_dot2c_f32_bf16 v42, v16, v16
    v_dot2c_f32_bf16 v41, v17, v44
    v_dot2c_f32_bf16 v43, v17, v17
    v_dot2c_f32_bf16 v40, v18, v44
    v_dot2c_f32_bf16 v42, v18, v18
    v_dot2c_f32_bf16 v41, v19, v44
    v_dot2c_f32_bf16 v43, v19, v19
    s_waitcnt vmcnt(4)
    v_dot2c_f32_bf16 v40, v20, v44
    v_dot2c_f32_bf16 v42, v20, v20
    v_dot2c_f32_bf16 v41, v21, v44
    v_dot2c_f32_bf16 v43, v21, v21
    v_dot2c_f32_bf16 v40, v22, v44
    v_dot2c_f32_bf16 v42, v22, v22
    v_dot2c_f32_bf16 v41, v23, v44
    v_dot2c_f32_bf16 v43, v23, v23
    s_nop 1
    v_add_f32 v40, v40, v41
    v_add_f32 v42, v42, v43
    s_nop 1
    v_add_f32_dpp v40, v40, v40 quad_perm:[1,0,3,2] row_mask:0xf bank_mask:0xf
    v_add_f32_dpp v42, v42, v42 quad_perm:[1,0,3,2] row_mask:0xf bank_mask:0xf
    s_nop 0
    v_add_f32_dpp v40, v40, v40 quad_perm:[2,3,0,1] row_mask:0xf bank_mask:0xf
    v_add_f32_dpp v42, v42, v42 quad_perm:[2,3,0,1] row_mask:0xf bank_mask:0xf
    s_nop 0
    v_add_f32_dpp v40, v40, v40 row_half_mirror row_mask:0xf bank_mask:0xf
    v_add_f32_dpp v42, v42, v42 row_half_mirror row_mask:0xf bank_mask:0xf
    s_nop 0
    v_add_f32_dpp v40, v40, v40 row_mirror row_mask:0xf bank_mask:0xf
    v_add_f32_dpp v42, v42, v42 row_mirror row_mask:0xf bank_mask:0xf
    v_mul_f32 v40, 0x3b000000, v40
    v_mul_f32 v42, 0x3b000000, v42
    v_fma_f32 v42, -v40, v40, v42
    v_max_f32 v42, 0, v42
    v_add_f32 v42, 0x3727c5ac, v42
    v_rsq_f32 v42, v42
    s_nop 0
    v_mul_f32 v40, v40, v42
    v_sub_f32 v40, 0, v40
    v_lshlrev_b32 v58, 16, v8
    v_and_b32 v59, 0xffff0000, v8
    v_fma_f32 v58, v58, v42, v40
    v_fma_f32 v59, v59, v42, v40
    v_cvt_pk_bf16_f32 v8, v58, v59
    v_lshlrev_b32 v60, 16, v9
    v_and_b32 v61, 0xffff0000, v9
    v_fma_f32 v60, v60, v42, v40
    v_fma_f32 v61, v61, v42, v40
    v_cvt_pk_bf16_f32 v9, v60, v61
    v_lshlrev_b32 v58, 16, v10
    v_and_b32 v59, 0xffff0000, v10
    v_fma_f32 v58, v58, v42, v40
    v_fma_f32 v59, v59, v42, v40
    v_cvt_pk_bf16_f32 v10, v58, v59
    v_lshlrev_b32 v60, 16, v11
    v_and_b32 v61, 0xffff0000, v11
    v_fma_f32 v60, v60, v42, v40
    v_fma_f32 v61, v61, v42, v40
    v_cvt_pk_bf16_f32 v11, v60, v61
    ds_write_b128 v45, v[8:11] offset:0
    v_lshlrev_b32 v58, 16, v12
    v_and_b32 v59, 0xffff0000, v12
    v_fma_f32 v58, v58, v42, v40
    v_fma_f32 v59, v59, v42, v40
    v_cvt_pk_bf16_f32 v12, v58, v59
    v_lshlrev_b32 v60, 16, v13
    v_and_b32 v61, 0xffff0000, v13
    v_fma_f32 v60, v60, v42, v40
    v_fma_f32 v61, v61, v42, v40
    v_cvt_pk_bf16_f32 v13, v60, v61
    v_lshlrev_b32 v58, 16, v14
    v_and_b32 v59, 0xffff0000, v14
    v_fma_f32 v58, v58, v42, v40
    v_fma_f32 v59, v59, v42, v40
    v_cvt_pk_bf16_f32 v14, v58, v59
    v_lshlrev_b32 v60, 16, v15
    v_and_b32 v61, 0xffff0000, v15
    v_fma_f32 v60, v60, v42, v40
    v_fma_f32 v61, v61, v42, v40
    v_cvt_pk_bf16_f32 v15, v60, v61
    ds_write_b128 v45, v[12:15] offset:8192
    v_lshlrev_b32 v58, 16, v16
    v_and_b32 v59, 0xffff0000, v16
    v_fma_f32 v58, v58, v42, v40
    v_fma_f32 v59, v59, v42, v40
    v_cvt_pk_bf16_f32 v16, v58, v59
    v_lshlrev_b32 v60, 16, v17
    v_and_b32 v61, 0xffff0000, v17
    v_fma_f32 v60, v60, v42, v40
    v_fma_f32 v61, v61, v42, v40
    v_cvt_pk_bf16_f32 v17, v60, v61
    v_lshlrev_b32 v58, 16, v18
    v_and_b32 v59, 0xffff0000, v18
    v_fma_f32 v58, v58, v42, v40
    v_fma_f32 v59, v59, v42, v40
    v_cvt_pk_bf16_f32 v18, v58, v59
    v_lshlrev_b32 v60, 16, v19
    v_and_b32 v61, 0xffff0000, v19
    v_fma_f32 v60, v60, v42, v40
    v_fma_f32 v61, v61, v42, v40
    v_cvt_pk_bf16_f32 v19, v60, v61
    ds_write_b128 v45, v[16:19] offset:16384
    v_lshlrev_b32 v58, 16, v20
    v_and_b32 v59, 0xffff0000, v20
    v_fma_f32 v58, v58, v42, v40
    v_fma_f32 v59, v59, v42, v40
    v_cvt_pk_bf16_f32 v20, v58, v59
    v_lshlrev_b32 v60, 16, v21
    v_and_b32 v61, 0xffff0000, v21
    v_fma_f32 v60, v60, v42, v40
    v_fma_f32 v61, v61, v42, v40
    v_cvt_pk_bf16_f32 v21, v60, v61
    v_lshlrev_b32 v58, 16, v22
    v_and_b32 v59, 0xffff0000, v22
    v_fma_f32 v58, v58, v42, v40
    v_fma_f32 v59, v59, v42, v40
    v_cvt_pk_bf16_f32 v22, v58, v59
    v_lshlrev_b32 v60, 16, v23
    v_and_b32 v61, 0xffff0000, v23
    v_fma_f32 v60, v60, v42, v40
    v_fma_f32 v61, v61, v42, v40
    v_cvt_pk_bf16_f32 v23, v60, v61
    ds_write_b128 v45, v[20:23] offset:24576
    v_mov_b32 v40, 0
    v_mov_b32 v41, 0
    v_mov_b32 v42, 0
    v_mov_b32 v43, 0
    s_waitcnt vmcnt(3)
    v_dot2c_f32_bf16 v40, v24, v44
    v_dot2c_f32_bf16 v42, v24, v24
    v_dot2c_f32_bf16 v41, v25, v44
    v_dot2c_f32_bf16 v43, v25, v25
    v_dot2c_f32_bf16 v40, v26, v44
    v_dot2c_f32_bf16 v42, v26, v26
    v_dot2c_f32_bf16 v41, v27, v44
    v_dot2c_f32_bf16 v43, v27, v27
    s_waitcnt vmcnt(2)
    v_dot2c_f32_bf16 v40, v28, v44
    v_dot2c_f32_bf16 v42, v28, v28
    v_dot2c_f32_bf16 v41, v29, v44
    v_dot2c_f32_bf16 v43, v29, v29
    v_dot2c_f32_bf16 v40, v30, v44
    v_dot2c_f32_bf16 v42, v30, v30
    v_dot2c_f32_bf16 v41, v31, v44
    v_dot2c_f32_bf16 v43, v31, v31
    s_waitcnt vmcnt(1)
    v_dot2c_f32_bf16 v40, v32, v44
    v_dot2c_f32_bf16 v42, v32, v32
    v_dot2c_f32_bf16 v41, v33, v44
    v_dot2c_f32_bf16 v43, v33, v33
    v_dot2c_f32_bf16 v40, v34, v44
    v_dot2c_f32_bf16 v42, v34, v34
    v_dot2c_f32_bf16 v41, v35, v44
    v_dot2c_f32_bf16 v43, v35, v35
    s_waitcnt vmcnt(0)
    v_dot2c_f32_bf16 v40, v36, v44
    v_dot2c_f32_bf16 v42, v36, v36
    v_dot2c_f32_bf16 v41, v37, v44
    v_dot2c_f32_bf16 v43, v37, v37
    v_dot2c_f32_bf16 v40, v38, v44
    v_dot2c_f32_bf16 v42, v38, v38
    v_dot2c_f32_bf16 v41, v39, v44
    v_dot2c_f32_bf16 v43, v39, v39
    s_add_u32 m0, s47, 0
    s_add_u32 s46, s44, 0
    buffer_load_dwordx4 v57, s[20:23], s46 offen lds
    s_add_u32 m0, s47, 1024
    s_add_u32 s46, s44, 16384
    buffer_load_dwordx4 v57, s[20:23], s46 offen lds
    s_add_u32 m0, s47, 2048
    s_add_u32 s46, s44, 32768
    buffer_load_dwordx4 v57, s[20:23], s46 offen lds
    s_add_u32 m0, s47, 3072
    s_add_u32 s46, s44, 49152
    buffer_load_dwordx4 v57, s[20:23], s46 offen lds
    v_add_f32 v40, v40, v41
    v_add_f32 v42, v42, v43
    s_nop 1
    v_add_f32_dpp v40, v40, v40 quad_perm:[1,0,3,2] row_mask:0xf bank_mask:0xf
    v_add_f32_dpp v42, v42, v42 quad_perm:[1,0,3,2] row_mask:0xf bank_mask:0xf
    s_nop 0
    v_add_f32_dpp v40, v40, v40 quad_perm:[2,3,0,1] row_mask:0xf bank_mask:0xf
    v_add_f32_dpp v42, v42, v42 quad_perm:[2,3,0,1] row_mask:0xf bank_mask:0xf
    s_nop 0
    v_add_f32_dpp v40, v40, v40 row_half_mirror row_mask:0xf bank_mask:0xf
    v_add_f32_dpp v42, v42, v42 row_half_mirror row_mask:0xf bank_mask:0xf
    s_nop 0
    v_add_f32_dpp v40, v40, v40 row_mirror row_mask:0xf bank_mask:0xf
    v_add_f32_dpp v42, v42, v42 row_mirror row_mask:0xf bank_mask:0xf
    v_mul_f32 v40, 0x3b000000, v40
    v_mul_f32 v42, 0x3b000000, v42
    v_fma_f32 v42, -v40, v40, v42
    v_max_f32 v42, 0, v42
    v_add_f32 v42, 0x3727c5ac, v42
    v_rsq_f32 v42, v42
    s_nop 0
    v_mul_f32 v40, v40, v42
    v_sub_f32 v40, 0, v40
    v_lshlrev_b32 v58, 16, v24
    v_and_b32 v59, 0xffff0000, v24
    v_fma_f32 v58, v58, v42, v40
    v_fma_f32 v59, v59, v42, v40
    v_cvt_pk_bf16_f32 v24, v58, v59
    v_lshlrev_b32 v60, 16, v25
    v_and_b32 v61, 0xffff0000, v25
    v_fma_f32 v60, v60, v42, v40
    v_fma_f32 v61, v61, v42, v40
    v_cvt_pk_bf16_f32 v25, v60, v61
    v_lshlrev_b32 v58, 16, v26
    v_and_b32 v59, 0xffff0000, v26
    v_fma_f32 v58, v58, v42, v40
    v_fma_f32 v59, v59, v42, v40
    v_cvt_pk_bf16_f32 v26, v58, v59
    v_lshlrev_b32 v60, 16, v27
    v_and_b32 v61, 0xffff0000, v27
    v_fma_f32 v60, v60, v42, v40
    v_fma_f32 v61, v61, v42, v40
    v_cvt_pk_bf16_f32 v27, v60, v61
    ds_write_b128 v7, v[24:27] offset:0
    s_add_u32 m0, s47, 4096
    s_add_u32 s46, s44, 65536
    buffer_load_dwordx4 v57, s[20:23], s46 offen lds
    s_add_u32 m0, s47, 5120
    s_add_u32 s46, s44, 81920
    buffer_load_dwordx4 v57, s[20:23], s46 offen lds
    s_add_u32 m0, s47, 6144
    s_add_u32 s46, s44, 98304
    buffer_load_dwordx4 v57, s[20:23], s46 offen lds
    s_add_u32 m0, s47, 7168
    s_add_u32 s46, s44, 114688
    buffer_load_dwordx4 v57, s[20:23], s46 offen lds
    v_lshlrev_b32 v58, 16, v28
    v_and_b32 v59, 0xffff0000, v28
    v_fma_f32 v58, v58, v42, v40
    v_fma_f32 v59, v59, v42, v40
    v_cvt_pk_bf16_f32 v28, v58, v59
    v_lshlrev_b32 v60, 16, v29
    v_and_b32 v61, 0xffff0000, v29
    v_fma_f32 v60, v60, v42, v40
    v_fma_f32 v61, v61, v42, v40
    v_cvt_pk_bf16_f32 v29, v60, v61
    v_lshlrev_b32 v58, 16, v30
    v_and_b32 v59, 0xffff0000, v30
    v_fma_f32 v58, v58, v42, v40
    v_fma_f32 v59, v59, v42, v40
    v_cvt_pk_bf16_f32 v30, v58, v59
    v_lshlrev_b32 v60, 16, v31
    v_and_b32 v61, 0xffff0000, v31
    v_fma_f32 v60, v60, v42, v40
    v_fma_f32 v61, v61, v42, v40
    v_cvt_pk_bf16_f32 v31, v60, v61
    ds_write_b128 v7, v[28:31] offset:8192
    s_add_u32 m0, s47, 8192
    s_add_u32 s46, s44, 131072
    buffer_load_dwordx4 v57, s[20:23], s46 offen lds
    s_add_u32 m0, s47, 9216
    s_add_u32 s46, s44, 147456
    buffer_load_dwordx4 v57, s[20:23], s46 offen lds
    s_add_u32 m0, s47, 10240
    s_add_u32 s46, s44, 163840
    buffer_load_dwordx4 v57, s[20:23], s46 offen lds
    s_add_u32 m0, s45, 0
    s_add_u32 s46, s44, 180224
    buffer_load_dwordx4 v57, s[20:23], s46 offen lds
    v_lshlrev_b32 v58, 16, v32
    v_and_b32 v59, 0xffff0000, v32
    v_fma_f32 v58, v58, v42, v40
    v_fma_f32 v59, v59, v42, v40
    v_cvt_pk_bf16_f32 v32, v58, v59
    v_lshlrev_b32 v60, 16, v33
    v_and_b32 v61, 0xffff0000, v33
    v_fma_f32 v60, v60, v42, v40
    v_fma_f32 v61, v61, v42, v40
    v_cvt_pk_bf16_f32 v33, v60, v61
    v_lshlrev_b32 v58, 16, v34
    v_and_b32 v59, 0xffff0000, v34
    v_fma_f32 v58, v58, v42, v40
    v_fma_f32 v59, v59, v42, v40
    v_cvt_pk_bf16_f32 v34, v58, v59
    v_lshlrev_b32 v60, 16, v35
    v_and_b32 v61, 0xffff0000, v35
    v_fma_f32 v60, v60, v42, v40
    v_fma_f32 v61, v61, v42, v40
    v_cvt_pk_bf16_f32 v35, v60, v61
    ds_write_b128 v7, v[32:35] offset:16384
    s_add_u32 m0, s45, 1024
    s_add_u32 s46, s44, 196608
    buffer_load_dwordx4 v57, s[20:23], s46 offen lds
    s_add_u32 m0, s45, 2048
    s_add_u32 s46, s44, 212992
    buffer_load_dwordx4 v57, s[20:23], s46 offen lds
    s_add_u32 m0, s45, 3072
    s_add_u32 s46, s44, 229376
    buffer_load_dwordx4 v57, s[20:23], s46 offen lds
    s_add_u32 m0, s49, 0
    s_add_u32 s46, s44, 245760
    buffer_load_dwordx4 v57, s[20:23], s46 offen lds
    v_lshlrev_b32 v58, 16, v36
    v_and_b32 v59, 0xffff0000, v36
    v_fma_f32 v58, v58, v42, v40
    v_fma_f32 v59, v59, v42, v40
    v_cvt_pk_bf16_f32 v36, v58, v59
    v_lshlrev_b32 v60, 16, v37
    v_and_b32 v61, 0xffff0000, v37
    v_fma_f32 v60, v60, v42, v40
    v_fma_f32 v61, v61, v42, v40
    v_cvt_pk_bf16_f32 v37, v60, v61
    v_lshlrev_b32 v58, 16, v38
    v_and_b32 v59, 0xffff0000, v38
    v_fma_f32 v58, v58, v42, v40
    v_fma_f32 v59, v59, v42, v40
    v_cvt_pk_bf16_f32 v38, v58, v59
    v_lshlrev_b32 v60, 16, v39
    v_and_b32 v61, 0xffff0000, v39
    v_fma_f32 v60, v60, v42, v40
    v_fma_f32 v61, v61, v42, v40
    v_cvt_pk_bf16_f32 v39, v60, v61
    ds_write_b128 v7, v[36:39] offset:24576
    v_mov_b32 v104, 100412
    v_mov_b32 v105, 1
    s_waitcnt lgkmcnt(0)
    s_mov_b64 exec, 1
    ds_add_u32 v104, v105
    s_mov_b64 exec, -1
    s_setprio 3
    s_waitcnt vmcnt(12)
    ds_read_b64_tr_b16 v[192:193], v107 offset:0
    ds_read_b64_tr_b16 v[194:195], v107 offset:256
    ds_read_b64_tr_b16 v[196:197], v107 offset:1024
    ds_read_b64_tr_b16 v[198:199], v107 offset:1280
    ds_read_b64_tr_b16 v[200:201], v107 offset:2048
    ds_read_b64_tr_b16 v[202:203], v107 offset:2304
    ds_read_b64_tr_b16 v[204:205], v107 offset:3072
    ds_read_b64_tr_b16 v[206:207], v107 offset:3328
    s_waitcnt vmcnt(8)
    ds_read_b64_tr_b16 v[208:209], v107 offset:4096
    ds_read_b64_tr_b16 v[210:211], v107 offset:4352
    ds_read_b64_tr_b16 v[212:213], v107 offset:5120
    ds_read_b64_tr_b16 v[214:215], v107 offset:5376
    ds_read_b64_tr_b16 v[216:217], v107 offset:6144
    ds_read_b64_tr_b16 v[218:219], v107 offset:6400
    ds_read_b64_tr_b16 v[220:221], v107 offset:7168
    ds_read_b64_tr_b16 v[222:223], v107 offset:7424
    s_waitcnt vmcnt(4)
    ds_read_b64_tr_b16 v[224:225], v107 offset:8192
    ds_read_b64_tr_b16 v[226:227], v107 offset:8448
    ds_read_b64_tr_b16 v[228:229], v107 offset:9216
    ds_read_b64_tr_b16 v[230:231], v107 offset:9472
    ds_read_b64_tr_b16 v[232:233], v107 offset:10240
    ds_read_b64_tr_b16 v[234:235], v107 offset:10496
    ds_read_b64_tr_b16 v[236:237], v106 offset:0
    ds_read_b64_tr_b16 v[238:239], v106 offset:256
    s_waitcnt vmcnt(0)
    ds_read_b64_tr_b16 v[240:241], v106 offset:1024
    ds_read_b64_tr_b16 v[242:243], v106 offset:1280
    ds_read_b64_tr_b16 v[244:245], v106 offset:2048
    ds_read_b64_tr_b16 v[246:247], v106 offset:2304
    ds_read_b64_tr_b16 v[248:249], v106 offset:3072
    ds_read_b64_tr_b16 v[250:251], v106 offset:3328
    ds_read_b64_tr_b16 v[252:253], v108 offset:0
    ds_read_b64_tr_b16 v[254:255], v108 offset:256
2:
    ds_read_b32 v105, v104
    s_waitcnt lgkmcnt(0)
    v_readfirstlane_b32 s40, v105
    s_nop 0
    s_cmp_ge_u32 s40, 8
    s_cbranch_scc0 2b
    v_mov_b32 v105, 1
    s_mov_b64 exec, 1
    ds_add_u32 v104, v105
    s_mov_b64 exec, -1
    ds_read_b128 v[128:131], v116 offset:0
    ds_read_b128 v[132:135], v120 offset:0
    ds_read_b128 v[136:139], v117 offset:0
    ds_read_b128 v[140:143], v121 offset:0
    ds_read_b128 v[144:147], v118 offset:0
    ds_read_b128 v[148:151], v122 offset:0
    ds_read_b128 v[152:155], v119 offset:0
    ds_read_b128 v[156:159], v123 offset:0
    ds_read_b128 v[160:163], v116 offset:4096
    ds_read_b128 v[164:167], v120 offset:4096
    ds_read_b128 v[168:171], v117 offset:4096
    ds_read_b128 v[172:175], v121 offset:4096
    s_waitcnt lgkmcnt(10)
    v_mfma_f32_32x32x16_bf16 v[80:95], v[192:195], v[132:135], 0
    ds_read_b128 v[176:179], v118 offset:4096
    ds_read_b128 v[180:183], v122 offset:4096
    v_mfma_f32_32x32x16_bf16 v[64:79], v[192:195], v[128:131], 0
    s_waitcnt lgkmcnt(10)
    v_mfma_f32_32x32x16_bf16 v[80:95], v[196:199], v[140:143], v[80:95]
    ds_read_b128 v[184:187], v119 offset:4096
    ds_read_b128 v[188:191], v123 offset:4096
    v_mfma_f32_32x32x16_bf16 v[64:79], v[196:199], v[136:139], v[64:79]
    s_waitcnt lgkmcnt(10)
    v_mfma_f32_32x32x16_bf16 v[80:95], v[200:203], v[148:151], v[80:95]
    ds_read_b128 v[128:131], v116 offset:8192
    ds_read_b128 v[132:135], v120 offset:8192
    v_mfma_f32_32x32x16_bf16 v[64:79], v[200:203], v[144:147], v[64:79]
    s_waitcnt lgkmcnt(10)
    v_mfma_f32_32x32x16_bf16 v[80:95], v[204:207], v[156:159], v[80:95]
    ds_read_b128 v[136:139], v117 offset:8192
    ds_read_b128 v[140:143], v121 offset:8192
    v_mfma_f32_32x32x16_bf16 v[64:79], v[204:207], v[152:155], v[64:79]
    s_waitcnt lgkmcnt(10)
    v_mfma_f32_32x32x16_bf16 v[80:95], v[208:211], v[164:167], v[80:95]
    ds_read_b128 v[144:147], v118 offset:8192
    ds_read_b128 v[148:151], v122 offset:8192
    v_mfma_f32_32x32x16_bf16 v[64:79], v[208:211], v[160:163], v[64:79]
    s_waitcnt lgkmcnt(10)
    v_mfma_f32_32x32x16_bf16 v[80:95], v[212:215], v[172:175], v[80:95]
    ds_read_b128 v[152:155], v119 offset:8192
    ds_read_b128 v[156:159], v123 offset:8192
    v_mfma_f32_32x32x16_bf16 v[64:79], v[212:215], v[168:171], v[64:79]
    s_waitcnt lgkmcnt(10)
    v_mfma_f32_32x32x16_bf16 v[80:95], v[216:219], v[180:183], v[80:95]
    ds_read_b128 v[160:163], v116 offset:12288
    ds_read_b128 v[164:167], v120 offset:12288
    v_mfma_f32_32x32x16_bf16 v[64:79], v[216:219], v[176:179], v[64:79]
    s_waitcnt lgkmcnt(10)
    v_mfma_f32_32x32x16_bf16 v[80:95], v[220:223], v[188:191], v[80:95]
    ds_read_b128 v[168:171], v117 offset:12288
    ds_read_b128 v[172:175], v121 offset:12288
    v_mfma_f32_32x32x16_bf16 v[64:79], v[220:223], v[184:187], v[64:79]
    s_waitcnt lgkmcnt(10)
    v_mfma_f32_32x32x16_bf16 v[80:95], v[224:227], v[132:135], v[80:95]
    ds_read_b128 v[176:179], v118 offset:12288
    ds_read_b128 v[180:183], v122 offset:12288
    v_mfma_f32_32x32x16_bf16 v[64:79], v[224:227], v[128:131], v[64:79]
    s_waitcnt lgkmcnt(10)
    v_mfma_f32_32x32x16_bf16 v[80:95], v[228:231], v[140:143], v[80:95]
    ds_read_b128 v[184:187], v119 offset:12288
    ds_read_b128 v[188:191], v123 offset:12288
    v_mfma_f32_32x32x16_bf16 v[64:79], v[228:231], v[136:139], v[64:79]
    s_waitcnt lgkmcnt(10)
    v_mfma_f32_32x32x16_bf16 v[80:95], v[232:235], v[148:151], v[80:95]
    v_mfma_f32_32x32x16_bf16 v[64:79], v[232:235], v[144:147], v[64:79]
    s_waitcnt lgkmcnt(8)
    v_mfma_f32_32x32x16_bf16 v[80:95], v[236:239], v[156:159], v[80:95]
    v_mfma_f32_32x32x16_bf16 v[64:79], v[236:239], v[152:155], v[64:79]
    s_waitcnt lgkmcnt(6)
    v_mfma_f32_32x32x16_bf16 v[80:95], v[240:243], v[164:167], v[80:95]
    v_mfma_f32_32x32x16_bf16 v[64:79], v[240:243], v[160:163], v[64:79]
    s_waitcnt lgkmcnt(4)
    v_mfma_f32_32x32x16_bf16 v[80:95], v[244:247], v[172:175], v[80:95]
    v_mfma_f32_32x32x16_bf16 v[64:79], v[244:247], v[168:171], v[64:79]
    s_waitcnt lgkmcnt(2)
    v_mfma_f32_32x32x16_bf16 v[80:95], v[248:251], v[180:183], v[80:95]
    v_mfma_f32_32x32x16_bf16 v[64:79], v[248:251], v[176:179], v[64:79]
    s_waitcnt lgkmcnt(0)
    v_mfma_f32_32x32x16_bf16 v[80:95], v[252:255], v[188:191], v[80:95]
    v_mfma_f32_32x32x16_bf16 v[64:79], v[252:255], v[184:187], v[64:79]
    s_xor_b32 s46, s45, 4096
    v_add_u32 v116, s46, v56
    s_lshl_b32 s40, s35, 2
    s_add_u32 s40, s40, 100416
    v_mov_b32 v117, s40
    v_xor_b32 v118, 4, v117
    v_mov_b32 v119, 1
    s_lshl_b32 s52, s42, 2
    s_add_u32 s52, s52, s43
    s_add_u32 s53, s52, 2
    s_lshl_b32 s40, s52, 11
    s_add_u32 s40, s40, 81920
    v_add_u32 v121, s40, v56
    ds_write_b128 v51, v[80:83] offset:0
    ds_write_b128 v51, v[84:87] offset:1024
    ds_write_b128 v51, v[88:91] offset:2048
    ds_write_b128 v51, v[92:95] offset:3072
    ds_write_b32 v117, v119
2:
    ds_read_b32 v119, v118
    s_waitcnt lgkmcnt(0)
    v_readfirstlane_b32 s40, v119
    s_nop 0
    s_cmp_eq_u32 s40, 1
    s_cbranch_scc0 2b
    ds_read_b128 v[80:83], v116 offset:0
    ds_read_b128 v[84:87], v116 offset:1024
    ds_read_b128 v[88:91], v116 offset:2048
    ds_read_b128 v[92:95], v116 offset:3072
    s_mov_b32 s16, s64
    s_and_b32 s17, s65, 0xffff
    s_mov_b32 s18, 1835008
    s_mov_b32 s19, 0x20000
    s_and_b32 s34, s2, 0
    s_lshl_b32 s34, s34, 3
    s_bfe_u32 s40, s2, 0x30003
    s_add_u32 s34, s34, s40
    s_bfe_u32 s33, s2, 0x30000
    s_lshl_b32 s33, s33, 2
    s_lshr_b32 s40, s2, 6
    s_add_u32 s33, s33, s40
    s_mov_b32 s40, 0x3eb8aa3b
    s_mov_b32 s41, 0x3eb8aa3b
    s_waitcnt lgkmcnt(0)
    v_pk_add_f32 v[64:65], v[64:65], v[80:81]
    v_pk_add_f32 v[66:67], v[66:67], v[82:83]
    v_pk_add_f32 v[68:69], v[68:69], v[84:85]
    v_pk_add_f32 v[70:71], v[70:71], v[86:87]
    v_pk_add_f32 v[72:73], v[72:73], v[88:89]
    v_pk_add_f32 v[74:75], v[74:75], v[90:91]
    v_pk_add_f32 v[76:77], v[76:77], v[92:93]
    v_pk_add_f32 v[78:79], v[78:79], v[94:95]
    v_pk_mul_f32 v[64:65], v[64:65], s[40:41]
    v_pk_mul_f32 v[66:67], v[66:67], s[40:41]
    v_pk_mul_f32 v[68:69], v[68:69], s[40:41]
    v_pk_mul_f32 v[70:71], v[70:71], s[40:41]
    v_pk_mul_f32 v[72:73], v[72:73], s[40:41]
    v_pk_mul_f32 v[74:75], v[74:75], s[40:41]
    v_pk_mul_f32 v[76:77], v[76:77], s[40:41]
    v_pk_mul_f32 v[78:79], v[78:79], s[40:41]
    v_cvt_pk_bf16_f32 v96, v64, v65
    v_cvt_pk_bf16_f32 v97, v66, v67
    v_cvt_pk_bf16_f32 v98, v68, v69
    v_cvt_pk_bf16_f32 v99, v70, v71
    v_cvt_pk_bf16_f32 v100, v72, v73
    v_cvt_pk_bf16_f32 v101, v74, v75
    v_cvt_pk_bf16_f32 v102, v76, v77
    v_cvt_pk_bf16_f32 v103, v78, v79
    ds_write_b128 v121, v[96:99]
    ds_write_b128 v121, v[100:103] offset:4096
    v_mov_b32 v8, 100404
    v_mov_b32 v9, 1
    s_mov_b64 exec, 1
    ds_add_u32 v8, v9
    s_mov_b64 exec, -1
    s_mul_i32 s46, s39, 448
    s_mul_i32 s47, s35, 12288
    s_add_u32 s47, s47, 118784
    s_mov_b32 s62, 8
    s_mov_b32 s55, 1
    v_mov_b32 v120, 100400
    v_mov_b32 v1, v56
    v_lshlrev_b32 v62, 5, v49
    v_lshl_add_u32 v62, v48, 3, v62
    v_mov_b32 v112, v52
    v_mov_b32 v113, v53
    v_mov_b32 v114, v54
    v_mov_b32 v115, v55
    s_and_b32 s40, s39, 1
    s_cmp_eq_u32 s35, 3
    s_cbranch_scc1 kf_fd
    s_lshl_b32 s40, s40, 6
    s_add_u32 s46, s46, s40
    s_lshl_b32 s41, s35, 7
    s_add_u32 s46, s46, s41
    v_lshrrev_b32 v57, 3, v2
    v_and_b32 v58, 2, v57
    v_lshlrev_b32 v58, 1, v58
    v_and_b32 v59, 7, v2
    v_xor_b32 v58, v58, v59
    v_lshlrev_b32 v58, 4, v58
    v_mul_u32_u24 v57, 3584, v57
    v_add_u32 v3, v57, v58
    v_add_u32 v6, 27648, v3
    v_lshl_add_u32 v57, v50, 7, v62
    v_add_u32 v57, s47, v57
    v_lshrrev_b32 v58, 1, v47
    v_lshlrev_b32 v58, 6, v58
    v_add_u32 v4, v57, v58
    v_xor_b32 v58, 64, v58
    v_add_u32 v5, v57, v58
    s_sub_u32 s20, s66, 2048
    s_subb_u32 s21, s67, 0
    s_and_b32 s21, s21, 0xffff
    s_mov_b32 s22, 1837056
    s_mov_b32 s23, 0x20000
2:
    ds_read_b32 v105, v104
    s_waitcnt lgkmcnt(0)
    v_readfirstlane_b32 s40, v105
    s_nop 0
    s_cmp_ge_u32 s40, 12
    s_cbranch_scc0 2b
    s_mov_b32 s55, 5
    s_call_b64 s[60:61], kf_pause
    s_lshr_b32 s49, s38, 3
    s_and_b32 s49, s49, 3
    s_mov_b32 s52, 8192
    s_add_u32 s40, s49, 0
    s_and_b32 s40, s40, 3
    s_mul_i32 s40, s40, 458752
    s_add_u32 s36, s46, s40
    s_add_u32 s40, s49, 1
    s_and_b32 s40, s40, 3
    s_mul_i32 s40, s40, 458752
    s_add_u32 s37, s46, s40
    s_add_u32 s40, s49, 2
    s_and_b32 s40, s40, 3
    s_mul_i32 s40, s40, 458752
    s_add_u32 s44, s46, s40
    s_add_u32 s40, s49, 3
    s_and_b32 s40, s40, 3
    s_mul_i32 s40, s40, 458752
    s_add_u32 s45, s46, s40
    s_lshl_b32 s40, s49, 13
    v_add_u32 v112, s40, v112
    v_add_u32 v113, s40, v113
    v_add_u32 v114, s40, v114
    v_add_u32 v115, s40, v115
    s_add_u32 m0, s47, 0
    s_add_u32 s48, s36, 0
    buffer_load_dwordx4 v3, s[16:19], s48 offen lds
    buffer_load_dwordx4 v6, s[16:19], s48 offen offset:1024 lds
    buffer_load_dwordx4 v3, s[20:23], s48 offen offset:2048 lds
    buffer_load_dwordx4 v6, s[20:23], s48 offen offset:3072 lds
    s_add_u32 m0, s47, 4096
    s_add_u32 s48, s36, 57344
    buffer_load_dwordx4 v3, s[16:19], s48 offen lds
    buffer_load_dwordx4 v6, s[16:19], s48 offen offset:1024 lds
    buffer_load_dwordx4 v3, s[20:23], s48 offen offset:2048 lds
    buffer_load_dwordx4 v6, s[20:23], s48 offen offset:3072 lds
    s_add_u32 m0, s47, 8192
    s_add_u32 s48, s36, 114688
    buffer_load_dwordx4 v3, s[16:19], s48 offen lds
    buffer_load_dwordx4 v6, s[16:19], s48 offen offset:1024 lds
    buffer_load_dwordx4 v3, s[20:23], s48 offen offset:2048 lds
    buffer_load_dwordx4 v6, s[20:23], s48 offen offset:3072 lds
    s_waitcnt vmcnt(8)
    s_setprio 0
    ds_read_b128 v[32:35], v112 offset:0
    ds_read_b128 v[36:39], v112 offset:32768
    ds_read_b64_tr_b16 v[16:17], v4 offset:0
    ds_read_b64_tr_b16 v[18:19], v4 offset:512
    ds_read_b64_tr_b16 v[20:21], v5 offset:0
    ds_read_b64_tr_b16 v[22:23], v5 offset:512
    ds_read_b64_tr_b16 v[24:25], v4 offset:2048
    ds_read_b64_tr_b16 v[26:27], v4 offset:2560
    ds_read_b64_tr_b16 v[28:29], v5 offset:2048
    ds_read_b64_tr_b16 v[30:31], v5 offset:2560
    s_waitcnt lgkmcnt(0)
    v_mfma_f32_32x32x16_bf16 v[128:143], v[16:19], v[32:35], 0
    s_add_u32 m0, s47, 0
    s_add_u32 s48, s36, 172032
    buffer_load_dwordx4 v3, s[16:19], s48 offen lds
    buffer_load_dwordx4 v6, s[16:19], s48 offen offset:1024 lds
    v_mfma_f32_32x32x16_bf16 v[144:159], v[16:19], v[36:39], 0
    buffer_load_dwordx4 v3, s[20:23], s48 offen offset:2048 lds
    buffer_load_dwordx4 v6, s[20:23], s48 offen offset:3072 lds
    ds_read_b128 v[56:59], v113 offset:0
    ds_read_b128 v[60:63], v113 offset:32768
    v_mfma_f32_32x32x16_bf16 v[160:175], v[20:23], v[32:35], 0
    s_waitcnt vmcnt(8)
    ds_read_b64_tr_b16 v[40:41], v4 offset:4096
    ds_read_b64_tr_b16 v[42:43], v4 offset:4608
    ds_read_b64_tr_b16 v[44:45], v5 offset:4096
    v_mfma_f32_32x32x16_bf16 v[176:191], v[20:23], v[36:39], 0
    ds_read_b64_tr_b16 v[46:47], v5 offset:4608
    ds_read_b64_tr_b16 v[48:49], v4 offset:6144
    ds_read_b64_tr_b16 v[50:51], v4 offset:6656
    v_mfma_f32_32x32x16_bf16 v[192:207], v[24:27], v[32:35], 0
    ds_read_b64_tr_b16 v[52:53], v5 offset:6144
    ds_read_b64_tr_b16 v[54:55], v5 offset:6656
    v_mfma_f32_32x32x16_bf16 v[208:223], v[24:27], v[36:39], 0
    v_mfma_f32_32x32x16_bf16 v[224:239], v[28:31], v[32:35], 0
    v_mfma_f32_32x32x16_bf16 v[240:255], v[28:31], v[36:39], 0
    s_mov_b32 s55, 5
    s_call_b64 s[60:61], kf_pause
    s_waitcnt lgkmcnt(0)
    v_mfma_f32_32x32x16_bf16 v[128:143], v[40:43], v[56:59], v[128:143]
    s_add_u32 m0, s47, 4096
    s_add_u32 s48, s36, 229376
    buffer_load_dwordx4 v3, s[16:19], s48 offen lds
    buffer_load_dwordx4 v6, s[16:19], s48 offen offset:1024 lds
    v_mfma_f32_32x32x16_bf16 v[144:159], v[40:43], v[60:63], v[144:159]
    buffer_load_dwordx4 v3, s[20:23], s48 offen offset:2048 lds
    buffer_load_dwordx4 v6, s[20:23], s48 offen offset:3072 lds
    ds_read_b128 v[32:35], v114 offset:0
    ds_read_b128 v[36:39], v114 offset:32768
    v_mfma_f32_32x32x16_bf16 v[160:175], v[44:47], v[56:59], v[160:175]
    s_waitcnt vmcnt(8)
    ds_read_b64_tr_b16 v[16:17], v4 offset:8192
    ds_read_b64_tr_b16 v[18:19], v4 offset:8704
    ds_read_b64_tr_b16 v[20:21], v5 offset:8192
    v_mfma_f32_32x32x16_bf16 v[176:191], v[44:47], v[60:63], v[176:191]
    ds_read_b64_tr_b16 v[22:23], v5 offset:8704
    ds_read_b64_tr_b16 v[24:25], v4 offset:10240
    ds_read_b64_tr_b16 v[26:27], v4 offset:10752
    v_mfma_f32_32x32x16_bf16 v[192:207], v[48:51], v[56:59], v[192:207]
    ds_read_b64_tr_b16 v[28:29], v5 offset:10240
    ds_read_b64_tr_b16 v[30:31], v5 offset:10752
    v_mfma_f32_32x32x16_bf16 v[208:223], v[48:51], v[60:63], v[208:223]
    v_mfma_f32_32x32x16_bf16 v[224:239], v[52:55], v[56:59], v[224:239]
    v_mfma_f32_32x32x16_bf16 v[240:255], v[52:55], v[60:63], v[240:255]
    s_waitcnt lgkmcnt(0)
    v_mfma_f32_32x32x16_bf16 v[128:143], v[16:19], v[32:35], v[128:143]
    s_add_u32 m0, s47, 8192
    s_add_u32 s48, s36, 286720
    buffer_load_dwordx4 v3, s[16:19], s48 offen lds
    buffer_load_dwordx4 v6, s[16:19], s48 offen offset:1024 lds
    v_mfma_f32_32x32x16_bf16 v[144:159], v[16:19], v[36:39], v[144:159]
    buffer_load_dwordx4 v3, s[20:23], s48 offen offset:2048 lds
    buffer_load_dwordx4 v6, s[20:23], s48 offen offset:3072 lds
    ds_read_b128 v[56:59], v115 offset:0
    ds_read_b128 v[60:63], v115 offset:32768
    v_mfma_f32_32x32x16_bf16 v[160:175], v[20:23], v[32:35], v[160:175]
    s_waitcnt vmcnt(8)
    ds_read_b64_tr_b16 v[40:41], v4 offset:0
    ds_read_b64_tr_b16 v[42:43], v4 offset:512
    ds_read_b64_tr_b16 v[44:45], v5 offset:0
    v_mfma_f32_32x32x16_bf16 v[176:191], v[20:23], v[36:39], v[176:191]
    ds_read_b64_tr_b16 v[46:47], v5 offset:512
    ds_read_b64_tr_b16 v[48:49], v4 offset:2048
    ds_read_b64_tr_b16 v[50:51], v4 offset:2560
    v_mfma_f32_32x32x16_bf16 v[192:207], v[24:27], v[32:35], v[192:207]
    ds_read_b64_tr_b16 v[52:53], v5 offset:2048
    ds_read_b64_tr_b16 v[54:55], v5 offset:2560
    v_mfma_f32_32x32x16_bf16 v[208:223], v[24:27], v[36:39], v[208:223]
    v_mfma_f32_32x32x16_bf16 v[224:239], v[28:31], v[32:35], v[224:239]
    v_mfma_f32_32x32x16_bf16 v[240:255], v[28:31], v[36:39], v[240:255]
    s_waitcnt lgkmcnt(0)
    v_mfma_f32_32x32x16_bf16 v[128:143], v[40:43], v[56:59], v[128:143]
    s_add_u32 m0, s47, 0
    s_add_u32 s48, s36, 344064
    buffer_load_dwordx4 v3, s[16:19], s48 offen lds
    buffer_load_dwordx4 v6, s[16:19], s48 offen offset:1024 lds
    v_mfma_f32_32x32x16_bf16 v[144:159], v[40:43], v[60:63], v[144:159]
    buffer_load_dwordx4 v3, s[20:23], s48 offen offset:2048 lds
    buffer_load_dwordx4 v6, s[20:23], s48 offen offset:3072 lds
    ds_read_b128 v[32:35], v112 offset:4096
    ds_read_b128 v[36:39], v112 offset:36864
    v_mfma_f32_32x32x16_bf16 v[160:175], v[44:47], v[56:59], v[160:175]
    s_waitcnt vmcnt(8)
    ds_read_b64_tr_b16 v[16:17], v4 offset:4096
    ds_read_b64_tr_b16 v[18:19], v4 offset:4608
    ds_read_b64_tr_b16 v[20:21], v5 offset:4096
    v_mfma_f32_32x32x16_bf16 v[176:191], v[44:47], v[60:63], v[176:191]
    ds_read_b64_tr_b16 v[22:23], v5 offset:4608
    ds_read_b64_tr_b16 v[24:25], v4 offset:6144
    ds_read_b64_tr_b16 v[26:27], v4 offset:6656
    v_mfma_f32_32x32x16_bf16 v[192:207], v[48:51], v[56:59], v[192:207]
    ds_read_b64_tr_b16 v[28:29], v5 offset:6144
    ds_read_b64_tr_b16 v[30:31], v5 offset:6656
    v_mfma_f32_32x32x16_bf16 v[208:223], v[48:51], v[60:63], v[208:223]
    v_mfma_f32_32x32x16_bf16 v[224:239], v[52:55], v[56:59], v[224:239]
    v_mfma_f32_32x32x16_bf16 v[240:255], v[52:55], v[60:63], v[240:255]
    s_waitcnt lgkmcnt(0)
    v_mfma_f32_32x32x16_bf16 v[128:143], v[16:19], v[32:35], v[128:143]
    s_add_u32 m0, s47, 4096
    s_add_u32 s48, s36, 401408
    buffer_load_dwordx4 v3, s[16:19], s48 offen lds
    buffer_load_dwordx4 v6, s[16:19], s48 offen offset:1024 lds
    v_mfma_f32_32x32x16_bf16 v[144:159], v[16:19], v[36:39], v[144:159]
    buffer_load_dwordx4 v3, s[20:23], s48 offen offset:2048 lds
    buffer_load_dwordx4 v6, s[20:23], s48 offen offset:3072 lds
    ds_read_b128 v[56:59], v113 offset:4096
    ds_read_b128 v[60:63], v113 offset:36864
    v_mfma_f32_32x32x16_bf16 v[160:175], v[20:23], v[32:35], v[160:175]
    s_waitcnt vmcnt(8)
    ds_read_b64_tr_b16 v[40:41], v4 offset:8192
    ds_read_b64_tr_b16 v[42:43], v4 offset:8704
    ds_read_b64_tr_b16 v[44:45], v5 offset:8192
    v_mfma_f32_32x32x16_bf16 v[176:191], v[20:23], v[36:39], v[176:191]
    ds_read_b64_tr_b16 v[46:47], v5 offset:8704
    ds_read_b64_tr_b16 v[48:49], v4 offset:10240
    ds_read_b64_tr_b16 v[50:51], v4 offset:10752
    v_mfma_f32_32x32x16_bf16 v[192:207], v[24:27], v[32:35], v[192:207]
    ds_read_b64_tr_b16 v[52:53], v5 offset:10240
    ds_read_b64_tr_b16 v[54:55], v5 offset:10752
    v_mfma_f32_32x32x16_bf16 v[208:223], v[24:27], v[36:39], v[208:223]
    v_mfma_f32_32x32x16_bf16 v[224:239], v[28:31], v[32:35], v[224:239]
    v_mfma_f32_32x32x16_bf16 v[240:255], v[28:31], v[36:39], v[240:255]
    s_waitcnt lgkmcnt(0)
    v_mfma_f32_32x32x16_bf16 v[128:143], v[40:43], v[56:59], v[128:143]
    s_add_u32 m0, s47, 8192
    s_add_u32 s48, s37, 0
    buffer_load_dwordx4 v3, s[16:19], s48 offen lds
    buffer_load_dwordx4 v6, s[16:19], s48 offen offset:1024 lds
    v_mfma_f32_32x32x16_bf16 v[144:159], v[40:43], v[60:63], v[144:159]
    buffer_load_dwordx4 v3, s[20:23], s48 offen offset:2048 lds
    buffer_load_dwordx4 v6, s[20:23], s48 offen offset:3072 lds
    ds_read_b128 v[32:35], v114 offset:4096
    ds_read_b128 v[36:39], v114 offset:36864
    v_mfma_f32_32x32x16_bf16 v[160:175], v[44:47], v[56:59], v[160:175]
    s_waitcnt vmcnt(8)
    ds_read_b64_tr_b16 v[16:17], v4 offset:0
    ds_read_b64_tr_b16 v[18:19], v4 offset:512
    ds_read_b64_tr_b16 v[20:21], v5 offset:0
    v_mfma_f32_32x32x16_bf16 v[176:191], v[44:47], v[60:63], v[176:191]
    ds_read_b64_tr_b16 v[22:23], v5 offset:512
    ds_read_b64_tr_b16 v[24:25], v4 offset:2048
    ds_read_b64_tr_b16 v[26:27], v4 offset:2560
    v_mfma_f32_32x32x16_bf16 v[192:207], v[48:51], v[56:59], v[192:207]
    ds_read_b64_tr_b16 v[28:29], v5 offset:2048
    ds_read_b64_tr_b16 v[30:31], v5 offset:2560
    v_mfma_f32_32x32x16_bf16 v[208:223], v[48:51], v[60:63], v[208:223]
    v_mfma_f32_32x32x16_bf16 v[224:239], v[52:55], v[56:59], v[224:239]
    v_mfma_f32_32x32x16_bf16 v[240:255], v[52:55], v[60:63], v[240:255]
    s_waitcnt lgkmcnt(0)
    v_mfma_f32_32x32x16_bf16 v[128:143], v[16:19], v[32:35], v[128:143]
    s_add_u32 m0, s47, 0
    s_add_u32 s48, s37, 57344
    buffer_load_dwordx4 v3, s[16:19], s48 offen lds
    buffer_load_dwordx4 v6, s[16:19], s48 offen offset:1024 lds
    v_mfma_f32_32x32x16_bf16 v[144:159], v[16:19], v[36:39], v[144:159]
    buffer_load_dwordx4 v3, s[20:23], s48 offen offset:2048 lds
    buffer_load_dwordx4 v6, s[20:23], s48 offen offset:3072 lds
    ds_read_b128 v[56:59], v115 offset:4096
    ds_read_b128 v[60:63], v115 offset:36864
    v_mfma_f32_32x32x16_bf16 v[160:175], v[20:23], v[32:35], v[160:175]
    s_waitcnt vmcnt(8)
    ds_read_b64_tr_b16 v[40:41], v4 offset:4096
    ds_read_b64_tr_b16 v[42:43], v4 offset:4608
    ds_read_b64_tr_b16 v[44:45], v5 offset:4096
    v_mfma_f32_32x32x16_bf16 v[176:191], v[20:23], v[36:39], v[176:191]
    ds_read_b64_tr_b16 v[46:47], v5 offset:4608
    ds_read_b64_tr_b16 v[48:49], v4 offset:6144
    ds_read_b64_tr_b16 v[50:51], v4 offset:6656
    v_mfma_f32_32x32x16_bf16 v[192:207], v[24:27], v[32:35], v[192:207]
    ds_read_b64_tr_b16 v[52:53], v5 offset:6144
    ds_read_b64_tr_b16 v[54:55], v5 offset:6656
    v_mfma_f32_32x32x16_bf16 v[208:223], v[24:27], v[36:39], v[208:223]
    v_mfma_f32_32x32x16_bf16 v[224:239], v[28:31], v[32:35], v[224:239]
    v_mfma_f32_32x32x16_bf16 v[240:255], v[28:31], v[36:39], v[240:255]
    s_waitcnt lgkmcnt(0)
    s_cmp_eq_u32 s49, 3
    s_cselect_b32 s40, 4294942720, s52
    s_setprio 3
    v_add_u32 v112, s40, v112
    v_add_u32 v113, s40, v113
    v_add_u32 v114, s40, v114
    v_add_u32 v115, s40, v115
    s_setprio 0
    v_mfma_f32_32x32x16_bf16 v[128:143], v[40:43], v[56:59], v[128:143]
    s_add_u32 m0, s47, 4096
    s_add_u32 s48, s37, 114688
    buffer_load_dwordx4 v3, s[16:19], s48 offen lds
    buffer_load_dwordx4 v6, s[16:19], s48 offen offset:1024 lds
    v_mfma_f32_32x32x16_bf16 v[144:159], v[40:43], v[60:63], v[144:159]
    buffer_load_dwordx4 v3, s[20:23], s48 offen offset:2048 lds
    buffer_load_dwordx4 v6, s[20:23], s48 offen offset:3072 lds
    ds_read_b128 v[32:35], v112 offset:0
    ds_read_b128 v[36:39], v112 offset:32768
    v_mfma_f32_32x32x16_bf16 v[160:175], v[44:47], v[56:59], v[160:175]
    s_waitcnt vmcnt(8)
    ds_read_b64_tr_b16 v[16:17], v4 offset:8192
    ds_read_b64_tr_b16 v[18:19], v4 offset:8704
    ds_read_b64_tr_b16 v[20:21], v5 offset:8192
    v_mfma_f32_32x32x16_bf16 v[176:191], v[44:47], v[60:63], v[176:191]
    ds_read_b64_tr_b16 v[22:23], v5 offset:8704
    ds_read_b64_tr_b16 v[24:25], v4 offset:10240
    ds_read_b64_tr_b16 v[26:27], v4 offset:10752
    v_mfma_f32_32x32x16_bf16 v[192:207], v[48:51], v[56:59], v[192:207]
    ds_read_b64_tr_b16 v[28:29], v5 offset:10240
    ds_read_b64_tr_b16 v[30:31], v5 offset:10752
    v_mfma_f32_32x32x16_bf16 v[208:223], v[48:51], v[60:63], v[208:223]
    v_mfma_f32_32x32x16_bf16 v[224:239], v[52:55], v[56:59], v[224:239]
    v_mfma_f32_32x32x16_bf16 v[240:255], v[52:55], v[60:63], v[240:255]
    s_waitcnt lgkmcnt(0)
    v_mfma_f32_32x32x16_bf16 v[128:143], v[16:19], v[32:35], v[128:143]
    s_add_u32 m0, s47, 8192
    s_add_u32 s48, s37, 172032
    buffer_load_dwordx4 v3, s[16:19], s48 offen lds
    buffer_load_dwordx4 v6, s[16:19], s48 offen offset:1024 lds
    v_mfma_f32_32x32x16_bf16 v[144:159], v[16:19], v[36:39], v[144:159]
    buffer_load_dwordx4 v3, s[20:23], s48 offen offset:2048 lds
    buffer_load_dwordx4 v6, s[20:23], s48 offen offset:3072 lds
    ds_read_b128 v[56:59], v113 offset:0
    ds_read_b128 v[60:63], v113 offset:32768
    v_mfma_f32_32x32x16_bf16 v[160:175], v[20:23], v[32:35], v[160:175]
    s_waitcnt vmcnt(8)
    ds_read_b64_tr_b16 v[40:41], v4 offset:0
    ds_read_b64_tr_b16 v[42:43], v4 offset:512
    ds_read_b64_tr_b16 v[44:45], v5 offset:0
    v_mfma_f32_32x32x16_bf16 v[176:191], v[20:23], v[36:39], v[176:191]
    ds_read_b64_tr_b16 v[46:47], v5 offset:512
    ds_read_b64_tr_b16 v[48:49], v4 offset:2048
    ds_read_b64_tr_b16 v[50:51], v4 offset:2560
    v_mfma_f32_32x32x16_bf16 v[192:207], v[24:27], v[32:35], v[192:207]
    ds_read_b64_tr_b16 v[52:53], v5 offset:2048
    ds_read_b64_tr_b16 v[54:55], v5 offset:2560
    v_mfma_f32_32x32x16_bf16 v[208:223], v[24:27], v[36:39], v[208:223]
    v_mfma_f32_32x32x16_bf16 v[224:239], v[28:31], v[32:35], v[224:239]
    v_mfma_f32_32x32x16_bf16 v[240:255], v[28:31], v[36:39], v[240:255]
    s_waitcnt lgkmcnt(0)
    v_mfma_f32_32x32x16_bf16 v[128:143], v[40:43], v[56:59], v[128:143]
    s_add_u32 m0, s47, 0
    s_add_u32 s48, s37, 229376
    buffer_load_dwordx4 v3, s[16:19], s48 offen lds
    buffer_load_dwordx4 v6, s[16:19], s48 offen offset:1024 lds
    v_mfma_f32_32x32x16_bf16 v[144:159], v[40:43], v[60:63], v[144:159]
    buffer_load_dwordx4 v3, s[20:23], s48 offen offset:2048 lds
    buffer_load_dwordx4 v6, s[20:23], s48 offen offset:3072 lds
    ds_read_b128 v[32:35], v114 offset:0
    ds_read_b128 v[36:39], v114 offset:32768
    v_mfma_f32_32x32x16_bf16 v[160:175], v[44:47], v[56:59], v[160:175]
    s_waitcnt vmcnt(8)
    ds_read_b64_tr_b16 v[16:17], v4 offset:4096
    ds_read_b64_tr_b16 v[18:19], v4 offset:4608
    ds_read_b64_tr_b16 v[20:21], v5 offset:4096
    v_mfma_f32_32x32x16_bf16 v[176:191], v[44:47], v[60:63], v[176:191]
    ds_read_b64_tr_b16 v[22:23], v5 offset:4608
    ds_read_b64_tr_b16 v[24:25], v4 offset:6144
    ds_read_b64_tr_b16 v[26:27], v4 offset:6656
    v_mfma_f32_32x32x16_bf16 v[192:207], v[48:51], v[56:59], v[192:207]
    ds_read_b64_tr_b16 v[28:29], v5 offset:6144
    ds_read_b64_tr_b16 v[30:31], v5 offset:6656
    v_mfma_f32_32x32x16_bf16 v[208:223], v[48:51], v[60:63], v[208:223]
    v_mfma_f32_32x32x16_bf16 v[224:239], v[52:55], v[56:59], v[224:239]
    v_mfma_f32_32x32x16_bf16 v[240:255], v[52:55], v[60:63], v[240:255]
    s_waitcnt lgkmcnt(0)
    v_mfma_f32_32x32x16_bf16 v[128:143], v[16:19], v[32:35], v[128:143]
    s_add_u32 m0, s47, 4096
    s_add_u32 s48, s37, 286720
    buffer_load_dwordx4 v3, s[16:19], s48 offen lds
    buffer_load_dwordx4 v6, s[16:19], s48 offen offset:1024 lds
    v_mfma_f32_32x32x16_bf16 v[144:159], v[16:19], v[36:39], v[144:159]
    buffer_load_dwordx4 v3, s[20:23], s48 offen offset:2048 lds
    buffer_load_dwordx4 v6, s[20:23], s48 offen offset:3072 lds
    ds_read_b128 v[56:59], v115 offset:0
    ds_read_b128 v[60:63], v115 offset:32768
    v_mfma_f32_32x32x16_bf16 v[160:175], v[20:23], v[32:35], v[160:175]
    s_waitcnt vmcnt(8)
    ds_read_b64_tr_b16 v[40:41], v4 offset:8192
    ds_read_b64_tr_b16 v[42:43], v4 offset:8704
    ds_read_b64_tr_b16 v[44:45], v5 offset:8192
    v_mfma_f32_32x32x16_bf16 v[176:191], v[20:23], v[36:39], v[176:191]
    ds_read_b64_tr_b16 v[46:47], v5 offset:8704
    ds_read_b64_tr_b16 v[48:49], v4 offset:10240
    ds_read_b64_tr_b16 v[50:51], v4 offset:10752
    v_mfma_f32_32x32x16_bf16 v[192:207], v[24:27], v[32:35], v[192:207]
    ds_read_b64_tr_b16 v[52:53], v5 offset:10240
    ds_read_b64_tr_b16 v[54:55], v5 offset:10752
    v_mfma_f32_32x32x16_bf16 v[208:223], v[24:27], v[36:39], v[208:223]
    v_mfma_f32_32x32x16_bf16 v[224:239], v[28:31], v[32:35], v[224:239]
    v_mfma_f32_32x32x16_bf16 v[240:255], v[28:31], v[36:39], v[240:255]
    s_waitcnt lgkmcnt(0)
    v_mfma_f32_32x32x16_bf16 v[128:143], v[40:43], v[56:59], v[128:143]
    s_add_u32 m0, s47, 8192
    s_add_u32 s48, s37, 344064
    buffer_load_dwordx4 v3, s[16:19], s48 offen lds
    buffer_load_dwordx4 v6, s[16:19], s48 offen offset:1024 lds
    v_mfma_f32_32x32x16_bf16 v[144:159], v[40:43], v[60:63], v[144:159]
    buffer_load_dwordx4 v3, s[20:23], s48 offen offset:2048 lds
    buffer_load_dwordx4 v6, s[20:23], s48 offen offset:3072 lds
    ds_read_b128 v[32:35], v112 offset:4096
    ds_read_b128 v[36:39], v112 offset:36864
    v_mfma_f32_32x32x16_bf16 v[160:175], v[44:47], v[56:59], v[160:175]
    s_waitcnt vmcnt(8)
    ds_read_b64_tr_b16 v[16:17], v4 offset:0
    ds_read_b64_tr_b16 v[18:19], v4 offset:512
    ds_read_b64_tr_b16 v[20:21], v5 offset:0
    v_mfma_f32_32x32x16_bf16 v[176:191], v[44:47], v[60:63], v[176:191]
    ds_read_b64_tr_b16 v[22:23], v5 offset:512
    ds_read_b64_tr_b16 v[24:25], v4 offset:2048
    ds_read_b64_tr_b16 v[26:27], v4 offset:2560
    v_mfma_f32_32x32x16_bf16 v[192:207], v[48:51], v[56:59], v[192:207]
    ds_read_b64_tr_b16 v[28:29], v5 offset:2048
    ds_read_b64_tr_b16 v[30:31], v5 offset:2560
    v_mfma_f32_32x32x16_bf16 v[208:223], v[48:51], v[60:63], v[208:223]
    v_mfma_f32_32x32x16_bf16 v[224:239], v[52:55], v[56:59], v[224:239]
    v_mfma_f32_32x32x16_bf16 v[240:255], v[52:55], v[60:63], v[240:255]
    s_waitcnt lgkmcnt(0)
    v_mfma_f32_32x32x16_bf16 v[128:143], v[16:19], v[32:35], v[128:143]
    s_add_u32 m0, s47, 0
    s_add_u32 s48, s37, 401408
    buffer_load_dwordx4 v3, s[16:19], s48 offen lds
    buffer_load_dwordx4 v6, s[16:19], s48 offen offset:1024 lds
    v_mfma_f32_32x32x16_bf16 v[144:159], v[16:19], v[36:39], v[144:159]
    buffer_load_dwordx4 v3, s[20:23], s48 offen offset:2048 lds
    buffer_load_dwordx4 v6, s[20:23], s48 offen offset:3072 lds
    ds_read_b128 v[56:59], v113 offset:4096
    ds_read_b128 v[60:63], v113 offset:36864
    v_mfma_f32_32x32x16_bf16 v[160:175], v[20:23], v[32:35], v[160:175]
    s_waitcnt vmcnt(8)
    ds_read_b64_tr_b16 v[40:41], v4 offset:4096
    ds_read_b64_tr_b16 v[42:43], v4 offset:4608
    ds_read_b64_tr_b16 v[44:45], v5 offset:4096
    v_mfma_f32_32x32x16_bf16 v[176:191], v[20:23], v[36:39], v[176:191]
    ds_read_b64_tr_b16 v[46:47], v5 offset:4608
    ds_read_b64_tr_b16 v[48:49], v4 offset:6144
    ds_read_b64_tr_b16 v[50:51], v4 offset:6656
    v_mfma_f32_32x32x16_bf16 v[192:207], v[24:27], v[32:35], v[192:207]
    ds_read_b64_tr_b16 v[52:53], v5 offset:6144
    ds_read_b64_tr_b16 v[54:55], v5 offset:6656
    v_mfma_f32_32x32x16_bf16 v[208:223], v[24:27], v[36:39], v[208:223]
    v_mfma_f32_32x32x16_bf16 v[224:239], v[28:31], v[32:35], v[224:239]
    v_mfma_f32_32x32x16_bf16 v[240:255], v[28:31], v[36:39], v[240:255]
    s_waitcnt lgkmcnt(0)
    v_mfma_f32_32x32x16_bf16 v[128:143], v[40:43], v[56:59], v[128:143]
    s_add_u32 m0, s47, 4096
    s_add_u32 s48, s44, 0
    buffer_load_dwordx4 v3, s[16:19], s48 offen lds
    buffer_load_dwordx4 v6, s[16:19], s48 offen offset:1024 lds
    v_mfma_f32_32x32x16_bf16 v[144:159], v[40:43], v[60:63], v[144:159]
    buffer_load_dwordx4 v3, s[20:23], s48 offen offset:2048 lds
    buffer_load_dwordx4 v6, s[20:23], s48 offen offset:3072 lds
    ds_read_b128 v[32:35], v114 offset:4096
    ds_read_b128 v[36:39], v114 offset:36864
    v_mfma_f32_32x32x16_bf16 v[160:175], v[44:47], v[56:59], v[160:175]
    s_waitcnt vmcnt(8)
    ds_read_b64_tr_b16 v[16:17], v4 offset:8192
    ds_read_b64_tr_b16 v[18:19], v4 offset:8704
    ds_read_b64_tr_b16 v[20:21], v5 offset:8192
    v_mfma_f32_32x32x16_bf16 v[176:191], v[44:47], v[60:63], v[176:191]
    ds_read_b64_tr_b16 v[22:23], v5 offset:8704
    ds_read_b64_tr_b16 v[24:25], v4 offset:10240
    ds_read_b64_tr_b16 v[26:27], v4 offset:10752
    v_mfma_f32_32x32x16_bf16 v[192:207], v[48:51], v[56:59], v[192:207]
    ds_read_b64_tr_b16 v[28:29], v5 offset:10240
    ds_read_b64_tr_b16 v[30:31], v5 offset:10752
    v_mfma_f32_32x32x16_bf16 v[208:223], v[48:51], v[60:63], v[208:223]
    v_mfma_f32_32x32x16_bf16 v[224:239], v[52:55], v[56:59], v[224:239]
    v_mfma_f32_32x32x16_bf16 v[240:255], v[52:55], v[60:63], v[240:255]
    s_waitcnt lgkmcnt(0)
    v_mfma_f32_32x32x16_bf16 v[128:143], v[16:19], v[32:35], v[128:143]
    s_add_u32 m0, s47, 8192
    s_add_u32 s48, s44, 57344
    buffer_load_dwordx4 v3, s[16:19], s48 offen lds
    buffer_load_dwordx4 v6, s[16:19], s48 offen offset:1024 lds
    v_mfma_f32_32x32x16_bf16 v[144:159], v[16:19], v[36:39], v[144:159]
    buffer_load_dwordx4 v3, s[20:23], s48 offen offset:2048 lds
    buffer_load_dwordx4 v6, s[20:23], s48 offen offset:3072 lds
    ds_read_b128 v[56:59], v115 offset:4096
    ds_read_b128 v[60:63], v115 offset:36864
    v_mfma_f32_32x32x16_bf16 v[160:175], v[20:23], v[32:35], v[160:175]
    s_waitcnt vmcnt(8)
    ds_read_b64_tr_b16 v[40:41], v4 offset:0
    ds_read_b64_tr_b16 v[42:43], v4 offset:512
    ds_read_b64_tr_b16 v[44:45], v5 offset:0
    v_mfma_f32_32x32x16_bf16 v[176:191], v[20:23], v[36:39], v[176:191]
    ds_read_b64_tr_b16 v[46:47], v5 offset:512
    ds_read_b64_tr_b16 v[48:49], v4 offset:2048
    ds_read_b64_tr_b16 v[50:51], v4 offset:2560
    v_mfma_f32_32x32x16_bf16 v[192:207], v[24:27], v[32:35], v[192:207]
    ds_read_b64_tr_b16 v[52:53], v5 offset:2048
    ds_read_b64_tr_b16 v[54:55], v5 offset:2560
    v_mfma_f32_32x32x16_bf16 v[208:223], v[24:27], v[36:39], v[208:223]
    v_mfma_f32_32x32x16_bf16 v[224:239], v[28:31], v[32:35], v[224:239]
    v_mfma_f32_32x32x16_bf16 v[240:255], v[28:31], v[36:39], v[240:255]
    s_waitcnt lgkmcnt(0)
    s_cmp_eq_u32 s49, 2
    s_cselect_b32 s40, 4294942720, s52
    s_setprio 3
    v_add_u32 v112, s40, v112
    v_add_u32 v113, s40, v113
    v_add_u32 v114, s40, v114
    v_add_u32 v115, s40, v115
    s_setprio 0
    v_mfma_f32_32x32x16_bf16 v[128:143], v[40:43], v[56:59], v[128:143]
    s_add_u32 m0, s47, 0
    s_add_u32 s48, s44, 114688
    buffer_load_dwordx4 v3, s[16:19], s48 offen lds
    buffer_load_dwordx4 v6, s[16:19], s48 offen offset:1024 lds
    v_mfma_f32_32x32x16_bf16 v[144:159], v[40:43], v[60:63], v[144:159]
    buffer_load_dwordx4 v3, s[20:23], s48 offen offset:2048 lds
    buffer_load_dwordx4 v6, s[20:23], s48 offen offset:3072 lds
    ds_read_b128 v[32:35], v112 offset:0
    ds_read_b128 v[36:39], v112 offset:32768
    v_mfma_f32_32x32x16_bf16 v[160:175], v[44:47], v[56:59], v[160:175]
    s_waitcnt vmcnt(8)
    ds_read_b64_tr_b16 v[16:17], v4 offset:4096
    ds_read_b64_tr_b16 v[18:19], v4 offset:4608
    ds_read_b64_tr_b16 v[20:21], v5 offset:4096
    v_mfma_f32_32x32x16_bf16 v[176:191], v[44:47], v[60:63], v[176:191]
    ds_read_b64_tr_b16 v[22:23], v5 offset:4608
    ds_read_b64_tr_b16 v[24:25], v4 offset:6144
    ds_read_b64_tr_b16 v[26:27], v4 offset:6656
    v_mfma_f32_32x32x16_bf16 v[192:207], v[48:51], v[56:59], v[192:207]
    ds_read_b64_tr_b16 v[28:29], v5 offset:6144
    ds_read_b64_tr_b16 v[30:31], v5 offset:6656
    v_mfma_f32_32x32x16_bf16 v[208:223], v[48:51], v[60:63], v[208:223]
    v_mfma_f32_32x32x16_bf16 v[224:239], v[52:55], v[56:59], v[224:239]
    v_mfma_f32_32x32x16_bf16 v[240:255], v[52:55], v[60:63], v[240:255]
    s_waitcnt lgkmcnt(0)
    v_mfma_f32_32x32x16_bf16 v[128:143], v[16:19], v[32:35], v[128:143]
    s_add_u32 m0, s47, 4096
    s_add_u32 s48, s44, 172032
    buffer_load_dwordx4 v3, s[16:19], s48 offen lds
    buffer_load_dwordx4 v6, s[16:19], s48 offen offset:1024 lds
    v_mfma_f32_32x32x16_bf16 v[144:159], v[16:19], v[36:39], v[144:159]
    buffer_load_dwordx4 v3, s[20:23], s48 offen offset:2048 lds
    buffer_load_dwordx4 v6, s[20:23], s48 offen offset:3072 lds
    ds_read_b128 v[56:59], v113 offset:0
    ds_read_b128 v[60:63], v113 offset:32768
    v_mfma_f32_32x32x16_bf16 v[160:175], v[20:23], v[32:35], v[160:175]
    s_waitcnt vmcnt(8)
    ds_read_b64_tr_b16 v[40:41], v4 offset:8192
    ds_read_b64_tr_b16 v[42:43], v4 offset:8704
    ds_read_b64_tr_b16 v[44:45], v5 offset:8192
    v_mfma_f32_32x32x16_bf16 v[176:191], v[20:23], v[36:39], v[176:191]
    ds_read_b64_tr_b16 v[46:47], v5 offset:8704
    ds_read_b64_tr_b16 v[48:49], v4 offset:10240
    ds_read_b64_tr_b16 v[50:51], v4 offset:10752
    v_mfma_f32_32x32x16_bf16 v[192:207], v[24:27], v[32:35], v[192:207]
    ds_read_b64_tr_b16 v[52:53], v5 offset:10240
    ds_read_b64_tr_b16 v[54:55], v5 offset:10752
    v_mfma_f32_32x32x16_bf16 v[208:223], v[24:27], v[36:39], v[208:223]
    v_mfma_f32_32x32x16_bf16 v[224:239], v[28:31], v[32:35], v[224:239]
    v_mfma_f32_32x32x16_bf16 v[240:255], v[28:31], v[36:39], v[240:255]
    s_waitcnt lgkmcnt(0)
    v_mfma_f32_32x32x16_bf16 v[128:143], v[40:43], v[56:59], v[128:143]
    s_add_u32 m0, s47, 8192
    s_add_u32 s48, s44, 229376
    buffer_load_dwordx4 v3, s[16:19], s48 offen lds
    buffer_load_dwordx4 v6, s[16:19], s48 offen offset:1024 lds
    v_mfma_f32_32x32x16_bf16 v[144:159], v[40:43], v[60:63], v[144:159]
    buffer_load_dwordx4 v3, s[20:23], s48 offen offset:2048 lds
    buffer_load_dwordx4 v6, s[20:23], s48 offen offset:3072 lds
    ds_read_b128 v[32:35], v114 offset:0
    ds_read_b128 v[36:39], v114 offset:32768
    v_mfma_f32_32x32x16_bf16 v[160:175], v[44:47], v[56:59], v[160:175]
    s_waitcnt vmcnt(8)
    ds_read_b64_tr_b16 v[16:17], v4 offset:0
    ds_read_b64_tr_b16 v[18:19], v4 offset:512
    ds_read_b64_tr_b16 v[20:21], v5 offset:0
    v_mfma_f32_32x32x16_bf16 v[176:191], v[44:47], v[60:63], v[176:191]
    ds_read_b64_tr_b16 v[22:23], v5 offset:512
    ds_read_b64_tr_b16 v[24:25], v4 offset:2048
    ds_read_b64_tr_b16 v[26:27], v4 offset:2560
    v_mfma_f32_32x32x16_bf16 v[192:207], v[48:51], v[56:59], v[192:207]
    ds_read_b64_tr_b16 v[28:29], v5 offset:2048
    ds_read_b64_tr_b16 v[30:31], v5 offset:2560
    v_mfma_f32_32x32x16_bf16 v[208:223], v[48:51], v[60:63], v[208:223]
    v_mfma_f32_32x32x16_bf16 v[224:239], v[52:55], v[56:59], v[224:239]
    v_mfma_f32_32x32x16_bf16 v[240:255], v[52:55], v[60:63], v[240:255]
    s_waitcnt lgkmcnt(0)
    v_mfma_f32_32x32x16_bf16 v[128:143], v[16:19], v[32:35], v[128:143]
    s_add_u32 m0, s47, 0
    s_add_u32 s48, s44, 286720
    buffer_load_dwordx4 v3, s[16:19], s48 offen lds
    buffer_load_dwordx4 v6, s[16:19], s48 offen offset:1024 lds
    v_mfma_f32_32x32x16_bf16 v[144:159], v[16:19], v[36:39], v[144:159]
    buffer_load_dwordx4 v3, s[20:23], s48 offen offset:2048 lds
    buffer_load_dwordx4 v6, s[20:23], s48 offen offset:3072 lds
    ds_read_b128 v[56:59], v115 offset:0
    ds_read_b128 v[60:63], v115 offset:32768
    v_mfma_f32_32x32x16_bf16 v[160:175], v[20:23], v[32:35], v[160:175]
    s_waitcnt vmcnt(8)
    ds_read_b64_tr_b16 v[40:41], v4 offset:4096
    ds_read_b64_tr_b16 v[42:43], v4 offset:4608
    ds_read_b64_tr_b16 v[44:45], v5 offset:4096
    v_mfma_f32_32x32x16_bf16 v[176:191], v[20:23], v[36:39], v[176:191]
    ds_read_b64_tr_b16 v[46:47], v5 offset:4608
    ds_read_b64_tr_b16 v[48:49], v4 offset:6144
    ds_read_b64_tr_b16 v[50:51], v4 offset:6656
    v_mfma_f32_32x32x16_bf16 v[192:207], v[24:27], v[32:35], v[192:207]
    ds_read_b64_tr_b16 v[52:53], v5 offset:6144
    ds_read_b64_tr_b16 v[54:55], v5 offset:6656
    v_mfma_f32_32x32x16_bf16 v[208:223], v[24:27], v[36:39], v[208:223]
    v_mfma_f32_32x32x16_bf16 v[224:239], v[28:31], v[32:35], v[224:239]
    v_mfma_f32_32x32x16_bf16 v[240:255], v[28:31], v[36:39], v[240:255]
    s_waitcnt lgkmcnt(0)
    v_mfma_f32_32x32x16_bf16 v[128:143], v[40:43], v[56:59], v[128:143]
    s_add_u32 m0, s47, 4096
    s_add_u32 s48, s44, 344064
    buffer_load_dwordx4 v3, s[16:19], s48 offen lds
    buffer_load_dwordx4 v6, s[16:19], s48 offen offset:1024 lds
    v_mfma_f32_32x32x16_bf16 v[144:159], v[40:43], v[60:63], v[144:159]
    buffer_load_dwordx4 v3, s[20:23], s48 offen offset:2048 lds
    buffer_load_dwordx4 v6, s[20:23], s48 offen offset:3072 lds
    ds_read_b128 v[32:35], v112 offset:4096
    ds_read_b128 v[36:39], v112 offset:36864
    v_mfma_f32_32x32x16_bf16 v[160:175], v[44:47], v[56:59], v[160:175]
    s_waitcnt vmcnt(8)
    ds_read_b64_tr_b16 v[16:17], v4 offset:8192
    ds_read_b64_tr_b16 v[18:19], v4 offset:8704
    ds_read_b64_tr_b16 v[20:21], v5 offset:8192
    v_mfma_f32_32x32x16_bf16 v[176:191], v[44:47], v[60:63], v[176:191]
    ds_read_b64_tr_b16 v[22:23], v5 offset:8704
    ds_read_b64_tr_b16 v[24:25], v4 offset:10240
    ds_read_b64_tr_b16 v[26:27], v4 offset:10752
    v_mfma_f32_32x32x16_bf16 v[192:207], v[48:51], v[56:59], v[192:207]
    ds_read_b64_tr_b16 v[28:29], v5 offset:10240
    ds_read_b64_tr_b16 v[30:31], v5 offset:10752
    v_mfma_f32_32x32x16_bf16 v[208:223], v[48:51], v[60:63], v[208:223]
    v_mfma_f32_32x32x16_bf16 v[224:239], v[52:55], v[56:59], v[224:239]
    v_mfma_f32_32x32x16_bf16 v[240:255], v[52:55], v[60:63], v[240:255]
    s_waitcnt lgkmcnt(0)
    v_mfma_f32_32x32x16_bf16 v[128:143], v[16:19], v[32:35], v[128:143]
    s_add_u32 m0, s47, 8192
    s_add_u32 s48, s44, 401408
    buffer_load_dwordx4 v3, s[16:19], s48 offen lds
    buffer_load_dwordx4 v6, s[16:19], s48 offen offset:1024 lds
    v_mfma_f32_32x32x16_bf16 v[144:159], v[16:19], v[36:39], v[144:159]
    buffer_load_dwordx4 v3, s[20:23], s48 offen offset:2048 lds
    buffer_load_dwordx4 v6, s[20:23], s48 offen offset:3072 lds
    ds_read_b128 v[56:59], v113 offset:4096
    ds_read_b128 v[60:63], v113 offset:36864
    v_mfma_f32_32x32x16_bf16 v[160:175], v[20:23], v[32:35], v[160:175]
    s_waitcnt vmcnt(8)
    ds_read_b64_tr_b16 v[40:41], v4 offset:0
    ds_read_b64_tr_b16 v[42:43], v4 offset:512
    ds_read_b64_tr_b16 v[44:45], v5 offset:0
    v_mfma_f32_32x32x16_bf16 v[176:191], v[20:23], v[36:39], v[176:191]
    ds_read_b64_tr_b16 v[46:47], v5 offset:512
    ds_read_b64_tr_b16 v[48:49], v4 offset:2048
    ds_read_b64_tr_b16 v[50:51], v4 offset:2560
    v_mfma_f32_32x32x16_bf16 v[192:207], v[24:27], v[32:35], v[192:207]
    ds_read_b64_tr_b16 v[52:53], v5 offset:2048
    ds_read_b64_tr_b16 v[54:55], v5 offset:2560
    v_mfma_f32_32x32x16_bf16 v[208:223], v[24:27], v[36:39], v[208:223]
    v_mfma_f32_32x32x16_bf16 v[224:239], v[28:31], v[32:35], v[224:239]
    v_mfma_f32_32x32x16_bf16 v[240:255], v[28:31], v[36:39], v[240:255]
    s_waitcnt lgkmcnt(0)
    v_mfma_f32_32x32x16_bf16 v[128:143], v[40:43], v[56:59], v[128:143]
    s_add_u32 m0, s47, 0
    s_add_u32 s48, s45, 0
    buffer_load_dwordx4 v3, s[16:19], s48 offen lds
    buffer_load_dwordx4 v6, s[16:19], s48 offen offset:1024 lds
    v_mfma_f32_32x32x16_bf16 v[144:159], v[40:43], v[60:63], v[144:159]
    buffer_load_dwordx4 v3, s[20:23], s48 offen offset:2048 lds
    buffer_load_dwordx4 v6, s[20:23], s48 offen offset:3072 lds
    ds_read_b128 v[32:35], v114 offset:4096
    ds_read_b128 v[36:39], v114 offset:36864
    v_mfma_f32_32x32x16_bf16 v[160:175], v[44:47], v[56:59], v[160:175]
    s_waitcnt vmcnt(8)
    ds_read_b64_tr_b16 v[16:17], v4 offset:4096
    ds_read_b64_tr_b16 v[18:19], v4 offset:4608
    ds_read_b64_tr_b16 v[20:21], v5 offset:4096
    v_mfma_f32_32x32x16_bf16 v[176:191], v[44:47], v[60:63], v[176:191]
    ds_read_b64_tr_b16 v[22:23], v5 offset:4608
    ds_read_b64_tr_b16 v[24:25], v4 offset:6144
    ds_read_b64_tr_b16 v[26:27], v4 offset:6656
    v_mfma_f32_32x32x16_bf16 v[192:207], v[48:51], v[56:59], v[192:207]
    ds_read_b64_tr_b16 v[28:29], v5 offset:6144
    ds_read_b64_tr_b16 v[30:31], v5 offset:6656
    v_mfma_f32_32x32x16_bf16 v[208:223], v[48:51], v[60:63], v[208:223]
    v_mfma_f32_32x32x16_bf16 v[224:239], v[52:55], v[56:59], v[224:239]
    v_mfma_f32_32x32x16_bf16 v[240:255], v[52:55], v[60:63], v[240:255]
    s_waitcnt lgkmcnt(0)
    v_mfma_f32_32x32x16_bf16 v[128:143], v[16:19], v[32:35], v[128:143]
    s_add_u32 m0, s47, 4096
    s_add_u32 s48, s45, 57344
    buffer_load_dwordx4 v3, s[16:19], s48 offen lds
    buffer_load_dwordx4 v6, s[16:19], s48 offen offset:1024 lds
    v_mfma_f32_32x32x16_bf16 v[144:159], v[16:19], v[36:39], v[144:159]
    buffer_load_dwordx4 v3, s[20:23], s48 offen offset:2048 lds
    buffer_load_dwordx4 v6, s[20:23], s48 offen offset:3072 lds
    ds_read_b128 v[56:59], v115 offset:4096
    ds_read_b128 v[60:63], v115 offset:36864
    v_mfma_f32_32x32x16_bf16 v[160:175], v[20:23], v[32:35], v[160:175]
    s_waitcnt vmcnt(8)
    ds_read_b64_tr_b16 v[40:41], v4 offset:8192
    ds_read_b64_tr_b16 v[42:43], v4 offset:8704
    ds_read_b64_tr_b16 v[44:45], v5 offset:8192
    v_mfma_f32_32x32x16_bf16 v[176:191], v[20:23], v[36:39], v[176:191]
    ds_read_b64_tr_b16 v[46:47], v5 offset:8704
    ds_read_b64_tr_b16 v[48:49], v4 offset:10240
    ds_read_b64_tr_b16 v[50:51], v4 offset:10752
    v_mfma_f32_32x32x16_bf16 v[192:207], v[24:27], v[32:35], v[192:207]
    ds_read_b64_tr_b16 v[52:53], v5 offset:10240
    ds_read_b64_tr_b16 v[54:55], v5 offset:10752
    v_mfma_f32_32x32x16_bf16 v[208:223], v[24:27], v[36:39], v[208:223]
    v_mfma_f32_32x32x16_bf16 v[224:239], v[28:31], v[32:35], v[224:239]
    v_mfma_f32_32x32x16_bf16 v[240:255], v[28:31], v[36:39], v[240:255]
    s_waitcnt lgkmcnt(0)
    s_cmp_eq_u32 s49, 1
    s_cselect_b32 s40, 4294942720, s52
    s_setprio 3
    v_add_u32 v112, s40, v112
    v_add_u32 v113, s40, v113
    v_add_u32 v114, s40, v114
    v_add_u32 v115, s40, v115
    s_setprio 0
    v_mfma_f32_32x32x16_bf16 v[128:143], v[40:43], v[56:59], v[128:143]
    s_add_u32 m0, s47, 8192
    s_add_u32 s48, s45, 114688
    buffer_load_dwordx4 v3, s[16:19], s48 offen lds
    buffer_load_dwordx4 v6, s[16:19], s48 offen offset:1024 lds
    v_mfma_f32_32x32x16_bf16 v[144:159], v[40:43], v[60:63], v[144:159]
    buffer_load_dwordx4 v3, s[20:23], s48 offen offset:2048 lds
    buffer_load_dwordx4 v6, s[20:23], s48 offen offset:3072 lds
    ds_read_b128 v[32:35], v112 offset:0
    ds_read_b128 v[36:39], v112 offset:32768
    v_mfma_f32_32x32x16_bf16 v[160:175], v[44:47], v[56:59], v[160:175]
    s_waitcnt vmcnt(8)
    ds_read_b64_tr_b16 v[16:17], v4 offset:0
    ds_read_b64_tr_b16 v[18:19], v4 offset:512
    ds_read_b64_tr_b16 v[20:21], v5 offset:0
    v_mfma_f32_32x32x16_bf16 v[176:191], v[44:47], v[60:63], v[176:191]
    ds_read_b64_tr_b16 v[22:23], v5 offset:512
    ds_read_b64_tr_b16 v[24:25], v4 offset:2048
    ds_read_b64_tr_b16 v[26:27], v4 offset:2560
    v_mfma_f32_32x32x16_bf16 v[192:207], v[48:51], v[56:59], v[192:207]
    ds_read_b64_tr_b16 v[28:29], v5 offset:2048
    ds_read_b64_tr_b16 v[30:31], v5 offset:2560
    v_mfma_f32_32x32x16_bf16 v[208:223], v[48:51], v[60:63], v[208:223]
    v_mfma_f32_32x32x16_bf16 v[224:239], v[52:55], v[56:59], v[224:239]
    v_mfma_f32_32x32x16_bf16 v[240:255], v[52:55], v[60:63], v[240:255]
    s_waitcnt lgkmcnt(0)
    v_mfma_f32_32x32x16_bf16 v[128:143], v[16:19], v[32:35], v[128:143]
    s_add_u32 m0, s47, 0
    s_add_u32 s48, s45, 172032
    buffer_load_dwordx4 v3, s[16:19], s48 offen lds
    buffer_load_dwordx4 v6, s[16:19], s48 offen offset:1024 lds
    v_mfma_f32_32x32x16_bf16 v[144:159], v[16:19], v[36:39], v[144:159]
    buffer_load_dwordx4 v3, s[20:23], s48 offen offset:2048 lds
    buffer_load_dwordx4 v6, s[20:23], s48 offen offset:3072 lds
    ds_read_b128 v[56:59], v113 offset:0
    ds_read_b128 v[60:63], v113 offset:32768
    v_mfma_f32_32x32x16_bf16 v[160:175], v[20:23], v[32:35], v[160:175]
    s_waitcnt vmcnt(8)
    ds_read_b64_tr_b16 v[40:41], v4 offset:4096
    ds_read_b64_tr_b16 v[42:43], v4 offset:4608
    ds_read_b64_tr_b16 v[44:45], v5 offset:4096
    v_mfma_f32_32x32x16_bf16 v[176:191], v[20:23], v[36:39], v[176:191]
    ds_read_b64_tr_b16 v[46:47], v5 offset:4608
    ds_read_b64_tr_b16 v[48:49], v4 offset:6144
    ds_read_b64_tr_b16 v[50:51], v4 offset:6656
    v_mfma_f32_32x32x16_bf16 v[192:207], v[24:27], v[32:35], v[192:207]
    ds_read_b64_tr_b16 v[52:53], v5 offset:6144
    ds_read_b64_tr_b16 v[54:55], v5 offset:6656
    v_mfma_f32_32x32x16_bf16 v[208:223], v[24:27], v[36:39], v[208:223]
    v_mfma_f32_32x32x16_bf16 v[224:239], v[28:31], v[32:35], v[224:239]
    v_mfma_f32_32x32x16_bf16 v[240:255], v[28:31], v[36:39], v[240:255]
    s_waitcnt lgkmcnt(0)
    v_mfma_f32_32x32x16_bf16 v[128:143], v[40:43], v[56:59], v[128:143]
    s_add_u32 m0, s47, 4096
    s_add_u32 s48, s45, 229376
    buffer_load_dwordx4 v3, s[16:19], s48 offen lds
    buffer_load_dwordx4 v6, s[16:19], s48 offen offset:1024 lds
    v_mfma_f32_32x32x16_bf16 v[144:159], v[40:43], v[60:63], v[144:159]
    buffer_load_dwordx4 v3, s[20:23], s48 offen offset:2048 lds
    buffer_load_dwordx4 v6, s[20:23], s48 offen offset:3072 lds
    ds_read_b128 v[32:35], v114 offset:0
    ds_read_b128 v[36:39], v114 offset:32768
    v_mfma_f32_32x32x16_bf16 v[160:175], v[44:47], v[56:59], v[160:175]
    s_waitcnt vmcnt(8)
    ds_read_b64_tr_b16 v[16:17], v4 offset:8192
    ds_read_b64_tr_b16 v[18:19], v4 offset:8704
    ds_read_b64_tr_b16 v[20:21], v5 offset:8192
    v_mfma_f32_32x32x16_bf16 v[176:191], v[44:47], v[60:63], v[176:191]
    ds_read_b64_tr_b16 v[22:23], v5 offset:8704
    ds_read_b64_tr_b16 v[24:25], v4 offset:10240
    ds_read_b64_tr_b16 v[26:27], v4 offset:10752
    v_mfma_f32_32x32x16_bf16 v[192:207], v[48:51], v[56:59], v[192:207]
    ds_read_b64_tr_b16 v[28:29], v5 offset:10240
    ds_read_b64_tr_b16 v[30:31], v5 offset:10752
    v_mfma_f32_32x32x16_bf16 v[208:223], v[48:51], v[60:63], v[208:223]
    v_mfma_f32_32x32x16_bf16 v[224:239], v[52:55], v[56:59], v[224:239]
    v_mfma_f32_32x32x16_bf16 v[240:255], v[52:55], v[60:63], v[240:255]
    s_waitcnt lgkmcnt(0)
    v_mfma_f32_32x32x16_bf16 v[128:143], v[16:19], v[32:35], v[128:143]
    s_add_u32 m0, s47, 8192
    s_add_u32 s48, s45, 286720
    buffer_load_dwordx4 v3, s[16:19], s48 offen lds
    buffer_load_dwordx4 v6, s[16:19], s48 offen offset:1024 lds
    v_mfma_f32_32x32x16_bf16 v[144:159], v[16:19], v[36:39], v[144:159]
    buffer_load_dwordx4 v3, s[20:23], s48 offen offset:2048 lds
    buffer_load_dwordx4 v6, s[20:23], s48 offen offset:3072 lds
    ds_read_b128 v[56:59], v115 offset:0
    ds_read_b128 v[60:63], v115 offset:32768
    v_mfma_f32_32x32x16_bf16 v[160:175], v[20:23], v[32:35], v[160:175]
    s_waitcnt vmcnt(8)
    ds_read_b64_tr_b16 v[40:41], v4 offset:0
    ds_read_b64_tr_b16 v[42:43], v4 offset:512
    ds_read_b64_tr_b16 v[44:45], v5 offset:0
    v_mfma_f32_32x32x16_bf16 v[176:191], v[20:23], v[36:39], v[176:191]
    ds_read_b64_tr_b16 v[46:47], v5 offset:512
    ds_read_b64_tr_b16 v[48:49], v4 offset:2048
    ds_read_b64_tr_b16 v[50:51], v4 offset:2560
    v_mfma_f32_32x32x16_bf16 v[192:207], v[24:27], v[32:35], v[192:207]
    ds_read_b64_tr_b16 v[52:53], v5 offset:2048
    ds_read_b64_tr_b16 v[54:55], v5 offset:2560
    v_mfma_f32_32x32x16_bf16 v[208:223], v[24:27], v[36:39], v[208:223]
    v_mfma_f32_32x32x16_bf16 v[224:239], v[28:31], v[32:35], v[224:239]
    v_mfma_f32_32x32x16_bf16 v[240:255], v[28:31], v[36:39], v[240:255]
    s_waitcnt lgkmcnt(0)
    v_mfma_f32_32x32x16_bf16 v[128:143], v[40:43], v[56:59], v[128:143]
    s_add_u32 m0, s47, 0
    s_add_u32 s48, s45, 344064
    buffer_load_dwordx4 v3, s[16:19], s48 offen lds
    buffer_load_dwordx4 v6, s[16:19], s48 offen offset:1024 lds
    v_mfma_f32_32x32x16_bf16 v[144:159], v[40:43], v[60:63], v[144:159]
    buffer_load_dwordx4 v3, s[20:23], s48 offen offset:2048 lds
    buffer_load_dwordx4 v6, s[20:23], s48 offen offset:3072 lds
    ds_read_b128 v[32:35], v112 offset:4096
    ds_read_b128 v[36:39], v112 offset:36864
    v_mfma_f32_32x32x16_bf16 v[160:175], v[44:47], v[56:59], v[160:175]
    s_waitcnt vmcnt(8)
    ds_read_b64_tr_b16 v[16:17], v4 offset:4096
    ds_read_b64_tr_b16 v[18:19], v4 offset:4608
    ds_read_b64_tr_b16 v[20:21], v5 offset:4096
    v_mfma_f32_32x32x16_bf16 v[176:191], v[44:47], v[60:63], v[176:191]
    ds_read_b64_tr_b16 v[22:23], v5 offset:4608
    ds_read_b64_tr_b16 v[24:25], v4 offset:6144
    ds_read_b64_tr_b16 v[26:27], v4 offset:6656
    v_mfma_f32_32x32x16_bf16 v[192:207], v[48:51], v[56:59], v[192:207]
    ds_read_b64_tr_b16 v[28:29], v5 offset:6144
    ds_read_b64_tr_b16 v[30:31], v5 offset:6656
    v_mfma_f32_32x32x16_bf16 v[208:223], v[48:51], v[60:63], v[208:223]
    v_mfma_f32_32x32x16_bf16 v[224:239], v[52:55], v[56:59], v[224:239]
    v_mfma_f32_32x32x16_bf16 v[240:255], v[52:55], v[60:63], v[240:255]
    s_waitcnt lgkmcnt(0)
    v_mfma_f32_32x32x16_bf16 v[128:143], v[16:19], v[32:35], v[128:143]
    s_add_u32 m0, s47, 4096
    s_add_u32 s48, s45, 401408
    buffer_load_dwordx4 v3, s[16:19], s48 offen lds
    buffer_load_dwordx4 v6, s[16:19], s48 offen offset:1024 lds
    v_mfma_f32_32x32x16_bf16 v[144:159], v[16:19], v[36:39], v[144:159]
    buffer_load_dwordx4 v3, s[20:23], s48 offen offset:2048 lds
    buffer_load_dwordx4 v6, s[20:23], s48 offen offset:3072 lds
    ds_read_b128 v[56:59], v113 offset:4096
    ds_read_b128 v[60:63], v113 offset:36864
    v_mfma_f32_32x32x16_bf16 v[160:175], v[20:23], v[32:35], v[160:175]
    s_waitcnt vmcnt(8)
    ds_read_b64_tr_b16 v[40:41], v4 offset:8192
    ds_read_b64_tr_b16 v[42:43], v4 offset:8704
    ds_read_b64_tr_b16 v[44:45], v5 offset:8192
    v_mfma_f32_32x32x16_bf16 v[176:191], v[20:23], v[36:39], v[176:191]
    ds_read_b64_tr_b16 v[46:47], v5 offset:8704
    ds_read_b64_tr_b16 v[48:49], v4 offset:10240
    ds_read_b64_tr_b16 v[50:51], v4 offset:10752
    v_mfma_f32_32x32x16_bf16 v[192:207], v[24:27], v[32:35], v[192:207]
    ds_read_b64_tr_b16 v[52:53], v5 offset:10240
    ds_read_b64_tr_b16 v[54:55], v5 offset:10752
    v_mfma_f32_32x32x16_bf16 v[208:223], v[24:27], v[36:39], v[208:223]
    v_mfma_f32_32x32x16_bf16 v[224:239], v[28:31], v[32:35], v[224:239]
    v_mfma_f32_32x32x16_bf16 v[240:255], v[28:31], v[36:39], v[240:255]
    s_waitcnt lgkmcnt(0)
    v_mfma_f32_32x32x16_bf16 v[128:143], v[40:43], v[56:59], v[128:143]
    v_mfma_f32_32x32x16_bf16 v[144:159], v[40:43], v[60:63], v[144:159]
    ds_read_b128 v[32:35], v114 offset:4096
    ds_read_b128 v[36:39], v114 offset:36864
    v_mfma_f32_32x32x16_bf16 v[160:175], v[44:47], v[56:59], v[160:175]
    s_waitcnt vmcnt(4)
    ds_read_b64_tr_b16 v[16:17], v4 offset:0
    ds_read_b64_tr_b16 v[18:19], v4 offset:512
    ds_read_b64_tr_b16 v[20:21], v5 offset:0
    v_mfma_f32_32x32x16_bf16 v[176:191], v[44:47], v[60:63], v[176:191]
    ds_read_b64_tr_b16 v[22:23], v5 offset:512
    ds_read_b64_tr_b16 v[24:25], v4 offset:2048
    ds_read_b64_tr_b16 v[26:27], v4 offset:2560
    v_mfma_f32_32x32x16_bf16 v[192:207], v[48:51], v[56:59], v[192:207]
    ds_read_b64_tr_b16 v[28:29], v5 offset:2048
    ds_read_b64_tr_b16 v[30:31], v5 offset:2560
    v_mfma_f32_32x32x16_bf16 v[208:223], v[48:51], v[60:63], v[208:223]
    v_mfma_f32_32x32x16_bf16 v[224:239], v[52:55], v[56:59], v[224:239]
    v_mfma_f32_32x32x16_bf16 v[240:255], v[52:55], v[60:63], v[240:255]
    s_waitcnt lgkmcnt(0)
    v_mfma_f32_32x32x16_bf16 v[128:143], v[16:19], v[32:35], v[128:143]
    v_mfma_f32_32x32x16_bf16 v[144:159], v[16:19], v[36:39], v[144:159]
    ds_read_b128 v[56:59], v115 offset:4096
    ds_read_b128 v[60:63], v115 offset:36864
    v_mfma_f32_32x32x16_bf16 v[160:175], v[20:23], v[32:35], v[160:175]
    s_waitcnt vmcnt(0)
    ds_read_b64_tr_b16 v[40:41], v4 offset:4096
    ds_read_b64_tr_b16 v[42:43], v4 offset:4608
    ds_read_b64_tr_b16 v[44:45], v5 offset:4096
    v_mfma_f32_32x32x16_bf16 v[176:191], v[20:23], v[36:39], v[176:191]
    ds_read_b64_tr_b16 v[46:47], v5 offset:4608
    ds_read_b64_tr_b16 v[48:49], v4 offset:6144
    ds_read_b64_tr_b16 v[50:51], v4 offset:6656
    v_mfma_f32_32x32x16_bf16 v[192:207], v[24:27], v[32:35], v[192:207]
    ds_read_b64_tr_b16 v[52:53], v5 offset:6144
    ds_read_b64_tr_b16 v[54:55], v5 offset:6656
    v_mfma_f32_32x32x16_bf16 v[208:223], v[24:27], v[36:39], v[208:223]
    v_mfma_f32_32x32x16_bf16 v[224:239], v[28:31], v[32:35], v[224:239]
    v_mfma_f32_32x32x16_bf16 v[240:255], v[28:31], v[36:39], v[240:255]
    s_waitcnt lgkmcnt(0)
    v_mfma_f32_32x32x16_bf16 v[128:143], v[40:43], v[56:59], v[128:143]
    v_mfma_f32_32x32x16_bf16 v[144:159], v[40:43], v[60:63], v[144:159]
    v_mfma_f32_32x32x16_bf16 v[160:175], v[44:47], v[56:59], v[160:175]
    v_mfma_f32_32x32x16_bf16 v[176:191], v[44:47], v[60:63], v[176:191]
    v_mfma_f32_32x32x16_bf16 v[192:207], v[48:51], v[56:59], v[192:207]
    v_mfma_f32_32x32x16_bf16 v[208:223], v[48:51], v[60:63], v[208:223]
    v_mfma_f32_32x32x16_bf16 v[224:239], v[52:55], v[56:59], v[224:239]
    v_mfma_f32_32x32x16_bf16 v[240:255], v[52:55], v[60:63], v[240:255]
    s_setprio 3
    s_nop 7
    s_lshr_b32 s40, s46, 5
    s_mul_i32 s41, s38, 224
    s_add_u32 s40, s40, s41
    s_lshl_b32 s40, s40, 10
    s_add_u32 s40, s40, 11010048
    s_add_u32 s41, s40, 114688
    v_max_f32 v128, 0, v128
    v_max_f32 v129, 0, v129
    v_max_f32 v130, 0, v130
    v_max_f32 v131, 0, v131
    v_max_f32 v132, 0, v132
    v_max_f32 v133, 0, v133
    v_max_f32 v134, 0, v134
    v_max_f32 v135, 0, v135
    v_max_f32 v136, 0, v136
    v_max_f32 v137, 0, v137
    v_max_f32 v138, 0, v138
    v_max_f32 v139, 0, v139
    v_max_f32 v140, 0, v140
    v_max_f32 v141, 0, v141
    v_max_f32 v142, 0, v142
    v_max_f32 v143, 0, v143
    v_pk_mul_f32 v[128:129], v[128:129], v[192:193]
    v_pk_mul_f32 v[130:131], v[130:131], v[194:195]
    v_pk_mul_f32 v[132:133], v[132:133], v[196:197]
    v_pk_mul_f32 v[134:135], v[134:135], v[198:199]
    v_pk_mul_f32 v[136:137], v[136:137], v[200:201]
    v_pk_mul_f32 v[138:139], v[138:139], v[202:203]
    v_pk_mul_f32 v[140:141], v[140:141], v[204:205]
    v_pk_mul_f32 v[142:143], v[142:143], v[206:207]
    v_cvt_pk_bf16_f32 v192, v128, v129
    v_cvt_pk_bf16_f32 v193, v130, v131
    v_cvt_pk_bf16_f32 v194, v132, v133
    v_cvt_pk_bf16_f32 v195, v134, v135
    v_cvt_pk_bf16_f32 v196, v136, v137
    v_cvt_pk_bf16_f32 v197, v138, v139
    v_cvt_pk_bf16_f32 v198, v140, v141
    v_cvt_pk_bf16_f32 v199, v142, v143
    buffer_store_dwordx4 v[192:195], v1, s[28:31], s40 offen offset:0 sc1
    buffer_store_dwordx4 v[196:199], v1, s[28:31], s40 offen offset:1024 sc1
    v_max_f32 v144, 0, v144
    v_max_f32 v145, 0, v145
    v_max_f32 v146, 0, v146
    v_max_f32 v147, 0, v147
    v_max_f32 v148, 0, v148
    v_max_f32 v149, 0, v149
    v_max_f32 v150, 0, v150
    v_max_f32 v151, 0, v151
    v_max_f32 v152, 0, v152
    v_max_f32 v153, 0, v153
    v_max_f32 v154, 0, v154
    v_max_f32 v155, 0, v155
    v_max_f32 v156, 0, v156
    v_max_f32 v157, 0, v157
    v_max_f32 v158, 0, v158
    v_max_f32 v159, 0, v159
    v_pk_mul_f32 v[144:145], v[144:145], v[208:209]
    v_pk_mul_f32 v[146:147], v[146:147], v[210:211]
    v_pk_mul_f32 v[148:149], v[148:149], v[212:213]
    v_pk_mul_f32 v[150:151], v[150:151], v[214:215]
    v_pk_mul_f32 v[152:153], v[152:153], v[216:217]
    v_pk_mul_f32 v[154:155], v[154:155], v[218:219]
    v_pk_mul_f32 v[156:157], v[156:157], v[220:221]
    v_pk_mul_f32 v[158:159], v[158:159], v[222:223]
    v_cvt_pk_bf16_f32 v208, v144, v145
    v_cvt_pk_bf16_f32 v209, v146, v147
    v_cvt_pk_bf16_f32 v210, v148, v149
    v_cvt_pk_bf16_f32 v211, v150, v151
    v_cvt_pk_bf16_f32 v212, v152, v153
    v_cvt_pk_bf16_f32 v213, v154, v155
    v_cvt_pk_bf16_f32 v214, v156, v157
    v_cvt_pk_bf16_f32 v215, v158, v159
    buffer_store_dwordx4 v[208:211], v1, s[28:31], s41 offen offset:0 sc1
    buffer_store_dwordx4 v[212:215], v1, s[28:31], s41 offen offset:1024 sc1
    v_max_f32 v160, 0, v160
    v_max_f32 v161, 0, v161
    v_max_f32 v162, 0, v162
    v_max_f32 v163, 0, v163
    v_max_f32 v164, 0, v164
    v_max_f32 v165, 0, v165
    v_max_f32 v166, 0, v166
    v_max_f32 v167, 0, v167
    v_max_f32 v168, 0, v168
    v_max_f32 v169, 0, v169
    v_max_f32 v170, 0, v170
    v_max_f32 v171, 0, v171
    v_max_f32 v172, 0, v172
    v_max_f32 v173, 0, v173
    v_max_f32 v174, 0, v174
    v_max_f32 v175, 0, v175
    v_pk_mul_f32 v[160:161], v[160:161], v[224:225]
    v_pk_mul_f32 v[162:163], v[162:163], v[226:227]
    v_pk_mul_f32 v[164:165], v[164:165], v[228:229]
    v_pk_mul_f32 v[166:167], v[166:167], v[230:231]
    v_pk_mul_f32 v[168:169], v[168:169], v[232:233]
    v_pk_mul_f32 v[170:171], v[170:171], v[234:235]
    v_pk_mul_f32 v[172:173], v[172:173], v[236:237]
    v_pk_mul_f32 v[174:175], v[174:175], v[238:239]
    v_cvt_pk_bf16_f32 v224, v160, v161
    v_cvt_pk_bf16_f32 v225, v162, v163
    v_cvt_pk_bf16_f32 v226, v164, v165
    v_cvt_pk_bf16_f32 v227, v166, v167
    v_cvt_pk_bf16_f32 v228, v168, v169
    v_cvt_pk_bf16_f32 v229, v170, v171
    v_cvt_pk_bf16_f32 v230, v172, v173
    v_cvt_pk_bf16_f32 v231, v174, v175
    buffer_store_dwordx4 v[224:227], v1, s[28:31], s40 offen offset:2048 sc1
    buffer_store_dwordx4 v[228:231], v1, s[28:31], s40 offen offset:3072 sc1
    v_max_f32 v176, 0, v176
    v_max_f32 v177, 0, v177
    v_max_f32 v178, 0, v178
    v_max_f32 v179, 0, v179
    v_max_f32 v180, 0, v180
    v_max_f32 v181, 0, v181
    v_max_f32 v182, 0, v182
    v_max_f32 v183, 0, v183
    v_max_f32 v184, 0, v184
    v_max_f32 v185, 0, v185
    v_max_f32 v186, 0, v186
    v_max_f32 v187, 0, v187
    v_max_f32 v188, 0, v188
    v_max_f32 v189, 0, v189
    v_max_f32 v190, 0, v190
    v_max_f32 v191, 0, v191
    v_pk_mul_f32 v[176:177], v[176:177], v[240:241]
    v_pk_mul_f32 v[178:179], v[178:179], v[242:243]
    v_pk_mul_f32 v[180:181], v[180:181], v[244:245]
    v_pk_mul_f32 v[182:183], v[182:183], v[246:247]
    v_pk_mul_f32 v[184:185], v[184:185], v[248:249]
    v_pk_mul_f32 v[186:187], v[186:187], v[250:251]
    v_pk_mul_f32 v[188:189], v[188:189], v[252:253]
    v_pk_mul_f32 v[190:191], v[190:191], v[254:255]
    v_cvt_pk_bf16_f32 v240, v176, v177
    v_cvt_pk_bf16_f32 v241, v178, v179
    v_cvt_pk_bf16_f32 v242, v180, v181
    v_cvt_pk_bf16_f32 v243, v182, v183
    v_cvt_pk_bf16_f32 v244, v184, v185
    v_cvt_pk_bf16_f32 v245, v186, v187
    v_cvt_pk_bf16_f32 v246, v188, v189
    v_cvt_pk_bf16_f32 v247, v190, v191
    buffer_store_dwordx4 v[240:243], v1, s[28:31], s41 offen offset:2048 sc1
    buffer_store_dwordx4 v[244:247], v1, s[28:31], s41 offen offset:3072 sc1
    s_branch kf_g2
kf_fd:
    s_xor_b32 s40, s40, 1
    s_mul_i32 s40, s40, 384
    s_add_u32 s46, s46, s40
    v_lshrrev_b32 v57, 2, v2
    v_mul_u32_u24 v57, 3584, v57
    v_lshl_add_u32 v3, v48, 4, v57
    v_add_u32 v6, 1024, v3
    v_lshl_add_u32 v57, v50, 6, v62
    v_add_u32 v4, s47, v57
    v_add_u32 v64, 82944, v1
    v_add_u32 v65, 65536, v1
    v_and_b32 v66, 31, v2
    v_lshlrev_b32 v66, 2, v66
    v_add_u32 v66, 98304, v66
    v_mov_b32 v67, 100352
    s_mov_b32 s62, 0
    s_lshl_b32 s63, s38, 16
    s_lshl_b32 s40, s39, 12
    s_add_u32 s63, s63, s40
    s_add_u32 s63, s63, 4718592
    s_sub_u32 s20, s66, 2048
    s_subb_u32 s21, s67, 0
    s_and_b32 s21, s21, 0xffff
    s_mov_b32 s22, 1837056
    s_mov_b32 s23, 0x20000
2:
    ds_read_b32 v105, v104
    s_waitcnt lgkmcnt(0)
    v_readfirstlane_b32 s40, v105
    s_nop 0
    s_cmp_ge_u32 s40, 12
    s_cbranch_scc0 2b
    s_mov_b32 s55, 5
    s_call_b64 s[60:61], kf_pause
    s_lshr_b32 s49, s38, 3
    s_and_b32 s49, s49, 3
    s_mov_b32 s52, 8192
    s_add_u32 s40, s49, 0
    s_and_b32 s40, s40, 3
    s_mul_i32 s40, s40, 458752
    s_add_u32 s36, s46, s40
    s_add_u32 s40, s49, 1
    s_and_b32 s40, s40, 3
    s_mul_i32 s40, s40, 458752
    s_add_u32 s37, s46, s40
    s_add_u32 s40, s49, 2
    s_and_b32 s40, s40, 3
    s_mul_i32 s40, s40, 458752
    s_add_u32 s44, s46, s40
    s_add_u32 s40, s49, 3
    s_and_b32 s40, s40, 3
    s_mul_i32 s40, s40, 458752
    s_add_u32 s45, s46, s40
    s_lshl_b32 s40, s49, 13
    v_add_u32 v112, s40, v112
    v_add_u32 v113, s40, v113
    v_add_u32 v114, s40, v114
    v_add_u32 v115, s40, v115
    s_add_u32 m0, s47, 0
    s_add_u32 s48, s36, 0
    buffer_load_dwordx4 v3, s[16:19], s48 offen lds
    buffer_load_dwordx4 v6, s[20:23], s48 offen offset:1024 lds
    s_add_u32 m0, s47, 2048
    s_add_u32 s48, s36, 57344
    buffer_load_dwordx4 v3, s[16:19], s48 offen lds
    buffer_load_dwordx4 v6, s[20:23], s48 offen offset:1024 lds
    s_add_u32 m0, s47, 4096
    s_add_u32 s48, s36, 114688
    buffer_load_dwordx4 v3, s[16:19], s48 offen lds
    buffer_load_dwordx4 v6, s[20:23], s48 offen offset:1024 lds
    s_add_u32 m0, s47, 6144
    s_add_u32 s48, s36, 172032
    buffer_load_dwordx4 v3, s[16:19], s48 offen lds
    buffer_load_dwordx4 v6, s[20:23], s48 offen offset:1024 lds
    v_mov_b32 v72, -1
    v_mov_b32 v73, -1
    v_mov_b32 v74, -1
    v_mov_b32 v75, -1
    s_add_u32 s59, s63, 32768
    v_lshlrev_b32 v118, 7, v2
    s_waitcnt vmcnt(6)
    s_setprio 0
    ds_read_b128 v[32:35], v112 offset:0
    ds_read_b128 v[36:39], v112 offset:32768
    ds_read_b64_tr_b16 v[16:17], v4 offset:0
    ds_read_b64_tr_b16 v[18:19], v4 offset:256
    ds_read_b64_tr_b16 v[20:21], v4 offset:1024
    ds_read_b64_tr_b16 v[22:23], v4 offset:1280
    s_waitcnt lgkmcnt(0)
    v_mfma_f32_32x32x16_bf16 v[128:143], v[16:19], v[32:35], 0
    s_add_u32 m0, s47, 0
    s_add_u32 s48, s36, 229376
    buffer_load_dwordx4 v3, s[16:19], s48 offen lds
    buffer_load_dwordx4 v6, s[20:23], s48 offen offset:1024 lds
    v_mfma_f32_32x32x16_bf16 v[144:159], v[16:19], v[36:39], 0
    ds_read_b128 v[56:59], v113 offset:0
    ds_read_b128 v[60:63], v113 offset:32768
    s_waitcnt vmcnt(6)
    ds_read_b64_tr_b16 v[40:41], v4 offset:2048
    v_mfma_f32_32x32x16_bf16 v[160:175], v[20:23], v[32:35], 0
    ds_read_b64_tr_b16 v[42:43], v4 offset:2304
    ds_read_b64_tr_b16 v[44:45], v4 offset:3072
    ds_read_b64_tr_b16 v[46:47], v4 offset:3328
    v_mfma_f32_32x32x16_bf16 v[176:191], v[20:23], v[36:39], 0
    s_mov_b32 s55, 5
    s_call_b64 s[60:61], kf_pause
    buffer_store_dwordx4 v[72:75], v1, s[28:31], s63 offen offset:0 sc1
    s_waitcnt lgkmcnt(0)
    v_mfma_f32_32x32x16_bf16 v[128:143], v[40:43], v[56:59], v[128:143]
    s_add_u32 m0, s47, 2048
    s_add_u32 s48, s36, 286720
    buffer_load_dwordx4 v3, s[16:19], s48 offen lds
    buffer_load_dwordx4 v6, s[20:23], s48 offen offset:1024 lds
    v_mfma_f32_32x32x16_bf16 v[144:159], v[40:43], v[60:63], v[144:159]
    ds_read_b128 v[32:35], v114 offset:0
    ds_read_b128 v[36:39], v114 offset:32768
    s_waitcnt vmcnt(6)
    ds_read_b64_tr_b16 v[16:17], v4 offset:4096
    v_mfma_f32_32x32x16_bf16 v[160:175], v[44:47], v[56:59], v[160:175]
    ds_read_b64_tr_b16 v[18:19], v4 offset:4352
    ds_read_b64_tr_b16 v[20:21], v4 offset:5120
    ds_read_b64_tr_b16 v[22:23], v4 offset:5376
    v_mfma_f32_32x32x16_bf16 v[176:191], v[44:47], v[60:63], v[176:191]
    buffer_store_dwordx4 v[72:75], v1, s[28:31], s59 offen offset:0 sc1
    s_waitcnt lgkmcnt(0)
    v_mfma_f32_32x32x16_bf16 v[128:143], v[16:19], v[32:35], v[128:143]
    s_add_u32 m0, s47, 4096
    s_add_u32 s48, s36, 344064
    buffer_load_dwordx4 v3, s[16:19], s48 offen lds
    buffer_load_dwordx4 v6, s[20:23], s48 offen offset:1024 lds
    v_mfma_f32_32x32x16_bf16 v[144:159], v[16:19], v[36:39], v[144:159]
    ds_read_b128 v[56:59], v115 offset:0
    ds_read_b128 v[60:63], v115 offset:32768
    s_waitcnt vmcnt(6)
    ds_read_b64_tr_b16 v[40:41], v4 offset:6144
    v_mfma_f32_32x32x16_bf16 v[160:175], v[20:23], v[32:35], v[160:175]
    ds_read_b64_tr_b16 v[42:43], v4 offset:6400
    ds_read_b64_tr_b16 v[44:45], v4 offset:7168
    ds_read_b64_tr_b16 v[46:47], v4 offset:7424
    v_mfma_f32_32x32x16_bf16 v[176:191], v[20:23], v[36:39], v[176:191]
    buffer_store_dwordx4 v[72:75], v1, s[28:31], s63 offen offset:1024 sc1
    s_waitcnt lgkmcnt(0)
    v_mfma_f32_32x32x16_bf16 v[128:143], v[40:43], v[56:59], v[128:143]
    s_add_u32 m0, s47, 6144
    s_add_u32 s48, s36, 401408
    buffer_load_dwordx4 v3, s[16:19], s48 offen lds
    buffer_load_dwordx4 v6, s[20:23], s48 offen offset:1024 lds
    v_mfma_f32_32x32x16_bf16 v[144:159], v[40:43], v[60:63], v[144:159]
    ds_read_b128 v[32:35], v112 offset:4096
    ds_read_b128 v[36:39], v112 offset:36864
    s_waitcnt vmcnt(6)
    ds_read_b64_tr_b16 v[16:17], v4 offset:0
    v_mfma_f32_32x32x16_bf16 v[160:175], v[44:47], v[56:59], v[160:175]
    ds_read_b64_tr_b16 v[18:19], v4 offset:256
    ds_read_b64_tr_b16 v[20:21], v4 offset:1024
    ds_read_b64_tr_b16 v[22:23], v4 offset:1280
    v_mfma_f32_32x32x16_bf16 v[176:191], v[44:47], v[60:63], v[176:191]
    buffer_store_dwordx4 v[72:75], v1, s[28:31], s59 offen offset:1024 sc1
    s_waitcnt lgkmcnt(0)
    v_mfma_f32_32x32x16_bf16 v[128:143], v[16:19], v[32:35], v[128:143]
    s_add_u32 m0, s47, 0
    s_add_u32 s48, s37, 0
    buffer_load_dwordx4 v3, s[16:19], s48 offen lds
    buffer_load_dwordx4 v6, s[20:23], s48 offen offset:1024 lds
    v_mfma_f32_32x32x16_bf16 v[144:159], v[16:19], v[36:39], v[144:159]
    ds_read_b128 v[56:59], v113 offset:4096
    ds_read_b128 v[60:63], v113 offset:36864
    s_waitcnt vmcnt(6)
    ds_read_b64_tr_b16 v[40:41], v4 offset:2048
    v_mfma_f32_32x32x16_bf16 v[160:175], v[20:23], v[32:35], v[160:175]
    ds_read_b64_tr_b16 v[42:43], v4 offset:2304
    ds_read_b64_tr_b16 v[44:45], v4 offset:3072
    ds_read_b64_tr_b16 v[46:47], v4 offset:3328
    v_mfma_f32_32x32x16_bf16 v[176:191], v[20:23], v[36:39], v[176:191]
    buffer_store_dwordx4 v[72:75], v1, s[28:31], s63 offen offset:2048 sc1
    s_waitcnt lgkmcnt(0)
    v_mfma_f32_32x32x16_bf16 v[128:143], v[40:43], v[56:59], v[128:143]
    s_add_u32 m0, s47, 2048
    s_add_u32 s48, s37, 57344
    buffer_load_dwordx4 v3, s[16:19], s48 offen lds
    buffer_load_dwordx4 v6, s[20:23], s48 offen offset:1024 lds
    v_mfma_f32_32x32x16_bf16 v[144:159], v[40:43], v[60:63], v[144:159]
    ds_read_b128 v[32:35], v114 offset:4096
    ds_read_b128 v[36:39], v114 offset:36864
    s_waitcnt vmcnt(6)
    ds_read_b64_tr_b16 v[16:17], v4 offset:4096
    v_mfma_f32_32x32x16_bf16 v[160:175], v[44:47], v[56:59], v[160:175]
    ds_read_b64_tr_b16 v[18:19], v4 offset:4352
    ds_read_b64_tr_b16 v[20:21], v4 offset:5120
    ds_read_b64_tr_b16 v[22:23], v4 offset:5376
    v_mfma_f32_32x32x16_bf16 v[176:191], v[44:47], v[60:63], v[176:191]
    buffer_store_dwordx4 v[72:75], v1, s[28:31], s59 offen offset:2048 sc1
    s_waitcnt lgkmcnt(0)
    v_mfma_f32_32x32x16_bf16 v[128:143], v[16:19], v[32:35], v[128:143]
    s_add_u32 m0, s47, 4096
    s_add_u32 s48, s37, 114688
    buffer_load_dwordx4 v3, s[16:19], s48 offen lds
    buffer_load_dwordx4 v6, s[20:23], s48 offen offset:1024 lds
    v_mfma_f32_32x32x16_bf16 v[144:159], v[16:19], v[36:39], v[144:159]
    ds_read_b128 v[56:59], v115 offset:4096
    ds_read_b128 v[60:63], v115 offset:36864
    s_waitcnt vmcnt(6)
    ds_read_b64_tr_b16 v[40:41], v4 offset:6144
    v_mfma_f32_32x32x16_bf16 v[160:175], v[20:23], v[32:35], v[160:175]
    ds_read_b64_tr_b16 v[42:43], v4 offset:6400
    ds_read_b64_tr_b16 v[44:45], v4 offset:7168
    ds_read_b64_tr_b16 v[46:47], v4 offset:7424
    v_mfma_f32_32x32x16_bf16 v[176:191], v[20:23], v[36:39], v[176:191]
    buffer_store_dwordx4 v[72:75], v1, s[28:31], s63 offen offset:3072 sc1
    s_waitcnt lgkmcnt(0)
    s_cmp_eq_u32 s49, 3
    s_cselect_b32 s40, 4294942720, s52
    s_setprio 3
    v_add_u32 v112, s40, v112
    v_add_u32 v113, s40, v113
    v_add_u32 v114, s40, v114
    v_add_u32 v115, s40, v115
    s_setprio 0
    v_mfma_f32_32x32x16_bf16 v[128:143], v[40:43], v[56:59], v[128:143]
    s_add_u32 m0, s47, 6144
    s_add_u32 s48, s37, 172032
    buffer_load_dwordx4 v3, s[16:19], s48 offen lds
    buffer_load_dwordx4 v6, s[20:23], s48 offen offset:1024 lds
    v_mfma_f32_32x32x16_bf16 v[144:159], v[40:43], v[60:63], v[144:159]
    ds_read_b128 v[32:35], v112 offset:0
    ds_read_b128 v[36:39], v112 offset:32768
    s_waitcnt vmcnt(6)
    ds_read_b64_tr_b16 v[16:17], v4 offset:0
    v_mfma_f32_32x32x16_bf16 v[160:175], v[44:47], v[56:59], v[160:175]
    ds_read_b64_tr_b16 v[18:19], v4 offset:256
    ds_read_b64_tr_b16 v[20:21], v4 offset:1024
    ds_read_b64_tr_b16 v[22:23], v4 offset:1280
    v_mfma_f32_32x32x16_bf16 v[176:191], v[44:47], v[60:63], v[176:191]
    buffer_store_dwordx4 v[72:75], v1, s[28:31], s59 offen offset:3072 sc1
    s_waitcnt lgkmcnt(0)
    v_mfma_f32_32x32x16_bf16 v[128:143], v[16:19], v[32:35], v[128:143]
    s_add_u32 m0, s47, 0
    s_add_u32 s48, s37, 229376
    buffer_load_dwordx4 v3, s[16:19], s48 offen lds
    buffer_load_dwordx4 v6, s[20:23], s48 offen offset:1024 lds
    v_mfma_f32_32x32x16_bf16 v[144:159], v[16:19], v[36:39], v[144:159]
    ds_read_b128 v[56:59], v113 offset:0
    ds_read_b128 v[60:63], v113 offset:32768
    s_waitcnt vmcnt(6)
    ds_read_b64_tr_b16 v[40:41], v4 offset:2048
    v_mfma_f32_32x32x16_bf16 v[160:175], v[20:23], v[32:35], v[160:175]
    ds_read_b64_tr_b16 v[42:43], v4 offset:2304
    ds_read_b64_tr_b16 v[44:45], v4 offset:3072
    ds_read_b64_tr_b16 v[46:47], v4 offset:3328
    v_mfma_f32_32x32x16_bf16 v[176:191], v[20:23], v[36:39], v[176:191]
    s_waitcnt lgkmcnt(0)
    v_mfma_f32_32x32x16_bf16 v[128:143], v[40:43], v[56:59], v[128:143]
    s_add_u32 m0, s47, 2048
    s_add_u32 s48, s37, 286720
    buffer_load_dwordx4 v3, s[16:19], s48 offen lds
    buffer_load_dwordx4 v6, s[20:23], s48 offen offset:1024 lds
    v_mfma_f32_32x32x16_bf16 v[144:159], v[40:43], v[60:63], v[144:159]
    ds_read_b128 v[32:35], v114 offset:0
    ds_read_b128 v[36:39], v114 offset:32768
    s_waitcnt vmcnt(6)
    ds_read_b64_tr_b16 v[16:17], v4 offset:4096
    v_mfma_f32_32x32x16_bf16 v[160:175], v[44:47], v[56:59], v[160:175]
    ds_read_b64_tr_b16 v[18:19], v4 offset:4352
    ds_read_b64_tr_b16 v[20:21], v4 offset:5120
    ds_read_b64_tr_b16 v[22:23], v4 offset:5376
    v_mfma_f32_32x32x16_bf16 v[176:191], v[44:47], v[60:63], v[176:191]
    s_call_b64 s[60:61], kf_merge
    s_mov_b32 s24, s68
    s_and_b32 s25, s69, 0xffff
    s_mov_b32 s26, 1835008
    s_mov_b32 s27, 0x20000
    s_mov_b32 s96, s72
    s_and_b32 s97, s73, 0xffff
    s_mov_b32 s98, 524288
    s_mov_b32 s99, 0x20000
    s_lshr_b32 s51, s2, 3
    s_mul_i32 s50, s51, 57344
    s_lshl_b32 s51, s51, 14
    s_and_b32 s53, s2, 7
    s_lshl_b32 s53, s53, 13
    s_cmp_ge_u32 s53, 57344
    s_cselect_b32 s53, 0, s53
    s_add_u32 s40, s50, s53
    s_add_u32 s53, s53, 8192
    buffer_load_dword v116, v118, s[24:27], s40 offen
    s_waitcnt lgkmcnt(0)
    v_mfma_f32_32x32x16_bf16 v[128:143], v[16:19], v[32:35], v[128:143]
    s_add_u32 m0, s47, 4096
    s_add_u32 s48, s37, 344064
    buffer_load_dwordx4 v3, s[16:19], s48 offen lds
    buffer_load_dwordx4 v6, s[20:23], s48 offen offset:1024 lds
    v_mfma_f32_32x32x16_bf16 v[144:159], v[16:19], v[36:39], v[144:159]
    ds_read_b128 v[56:59], v115 offset:0
    ds_read_b128 v[60:63], v115 offset:32768
    s_waitcnt vmcnt(6)
    ds_read_b64_tr_b16 v[40:41], v4 offset:6144
    v_mfma_f32_32x32x16_bf16 v[160:175], v[20:23], v[32:35], v[160:175]
    ds_read_b64_tr_b16 v[42:43], v4 offset:6400
    ds_read_b64_tr_b16 v[44:45], v4 offset:7168
    ds_read_b64_tr_b16 v[46:47], v4 offset:7424
    v_mfma_f32_32x32x16_bf16 v[176:191], v[20:23], v[36:39], v[176:191]
    s_waitcnt lgkmcnt(0)
    v_mfma_f32_32x32x16_bf16 v[128:143], v[40:43], v[56:59], v[128:143]
    s_add_u32 m0, s47, 6144
    s_add_u32 s48, s37, 401408
    buffer_load_dwordx4 v3, s[16:19], s48 offen lds
    buffer_load_dwordx4 v6, s[20:23], s48 offen offset:1024 lds
    v_mfma_f32_32x32x16_bf16 v[144:159], v[40:43], v[60:63], v[144:159]
    ds_read_b128 v[32:35], v112 offset:4096
    ds_read_b128 v[36:39], v112 offset:36864
    s_waitcnt vmcnt(6)
    ds_read_b64_tr_b16 v[16:17], v4 offset:0
    v_mfma_f32_32x32x16_bf16 v[160:175], v[44:47], v[56:59], v[160:175]
    ds_read_b64_tr_b16 v[18:19], v4 offset:256
    ds_read_b64_tr_b16 v[20:21], v4 offset:1024
    ds_read_b64_tr_b16 v[22:23], v4 offset:1280
    v_mfma_f32_32x32x16_bf16 v[176:191], v[44:47], v[60:63], v[176:191]
    s_call_b64 s[60:61], kf_merge
    s_cmp_ge_u32 s53, 57344
    s_cselect_b32 s53, 0, s53
    s_add_u32 s40, s50, s53
    s_add_u32 s53, s53, 8192
    buffer_load_dword v116, v118, s[24:27], s40 offen
    s_waitcnt lgkmcnt(0)
    v_mfma_f32_32x32x16_bf16 v[128:143], v[16:19], v[32:35], v[128:143]
    s_add_u32 m0, s47, 0
    s_add_u32 s48, s44, 0
    buffer_load_dwordx4 v3, s[16:19], s48 offen lds
    buffer_load_dwordx4 v6, s[20:23], s48 offen offset:1024 lds
    v_mfma_f32_32x32x16_bf16 v[144:159], v[16:19], v[36:39], v[144:159]
    ds_read_b128 v[56:59], v113 offset:4096
    ds_read_b128 v[60:63], v113 offset:36864
    s_waitcnt vmcnt(6)
    ds_read_b64_tr_b16 v[40:41], v4 offset:2048
    v_mfma_f32_32x32x16_bf16 v[160:175], v[20:23], v[32:35], v[160:175]
    ds_read_b64_tr_b16 v[42:43], v4 offset:2304
    ds_read_b64_tr_b16 v[44:45], v4 offset:3072
    ds_read_b64_tr_b16 v[46:47], v4 offset:3328
    v_mfma_f32_32x32x16_bf16 v[176:191], v[20:23], v[36:39], v[176:191]
    s_waitcnt lgkmcnt(0)
    v_mfma_f32_32x32x16_bf16 v[128:143], v[40:43], v[56:59], v[128:143]
    s_add_u32 m0, s47, 2048
    s_add_u32 s48, s44, 57344
    buffer_load_dwordx4 v3, s[16:19], s48 offen lds
    buffer_load_dwordx4 v6, s[20:23], s48 offen offset:1024 lds
    v_mfma_f32_32x32x16_bf16 v[144:159], v[40:43], v[60:63], v[144:159]
    ds_read_b128 v[32:35], v114 offset:4096
    ds_read_b128 v[36:39], v114 offset:36864
    s_waitcnt vmcnt(6)
    ds_read_b64_tr_b16 v[16:17], v4 offset:4096
    v_mfma_f32_32x32x16_bf16 v[160:175], v[44:47], v[56:59], v[160:175]
    ds_read_b64_tr_b16 v[18:19], v4 offset:4352
    ds_read_b64_tr_b16 v[20:21], v4 offset:5120
    ds_read_b64_tr_b16 v[22:23], v4 offset:5376
    v_mfma_f32_32x32x16_bf16 v[176:191], v[44:47], v[60:63], v[176:191]
    s_call_b64 s[60:61], kf_merge
    s_cmp_ge_u32 s53, 57344
    s_cselect_b32 s53, 0, s53
    s_add_u32 s40, s50, s53
    s_add_u32 s53, s53, 8192
    buffer_load_dword v116, v118, s[24:27], s40 offen
    s_waitcnt lgkmcnt(0)
    v_mfma_f32_32x32x16_bf16 v[128:143], v[16:19], v[32:35], v[128:143]
    s_add_u32 m0, s47, 4096
    s_add_u32 s48, s44, 114688
    buffer_load_dwordx4 v3, s[16:19], s48 offen lds
    buffer_load_dwordx4 v6, s[20:23], s48 offen offset:1024 lds
    v_mfma_f32_32x32x16_bf16 v[144:159], v[16:19], v[36:39], v[144:159]
    ds_read_b128 v[56:59], v115 offset:4096
    ds_read_b128 v[60:63], v115 offset:36864
    s_waitcnt vmcnt(6)
    ds_read_b64_tr_b16 v[40:41], v4 offset:6144
    v_mfma_f32_32x32x16_bf16 v[160:175], v[20:23], v[32:35], v[160:175]
    ds_read_b64_tr_b16 v[42:43], v4 offset:6400
    ds_read_b64_tr_b16 v[44:45], v4 offset:7168
    ds_read_b64_tr_b16 v[46:47], v4 offset:7424
    v_mfma_f32_32x32x16_bf16 v[176:191], v[20:23], v[36:39], v[176:191]
    s_waitcnt lgkmcnt(0)
    s_cmp_eq_u32 s49, 2
    s_cselect_b32 s40, 4294942720, s52
    s_setprio 3
    v_add_u32 v112, s40, v112
    v_add_u32 v113, s40, v113
    v_add_u32 v114, s40, v114
    v_add_u32 v115, s40, v115
    s_setprio 0
    v_mfma_f32_32x32x16_bf16 v[128:143], v[40:43], v[56:59], v[128:143]
    s_add_u32 m0, s47, 6144
    s_add_u32 s48, s44, 172032
    buffer_load_dwordx4 v3, s[16:19], s48 offen lds
    buffer_load_dwordx4 v6, s[20:23], s48 offen offset:1024 lds
    v_mfma_f32_32x32x16_bf16 v[144:159], v[40:43], v[60:63], v[144:159]
    ds_read_b128 v[32:35], v112 offset:0
    ds_read_b128 v[36:39], v112 offset:32768
    s_waitcnt vmcnt(6)
    ds_read_b64_tr_b16 v[16:17], v4 offset:0
    v_mfma_f32_32x32x16_bf16 v[160:175], v[44:47], v[56:59], v[160:175]
    ds_read_b64_tr_b16 v[18:19], v4 offset:256
    ds_read_b64_tr_b16 v[20:21], v4 offset:1024
    ds_read_b64_tr_b16 v[22:23], v4 offset:1280
    v_mfma_f32_32x32x16_bf16 v[176:191], v[44:47], v[60:63], v[176:191]
    s_call_b64 s[60:61], kf_merge
    s_cmp_ge_u32 s53, 57344
    s_cselect_b32 s53, 0, s53
    s_add_u32 s40, s50, s53
    s_add_u32 s53, s53, 8192
    buffer_load_dword v116, v118, s[24:27], s40 offen
    s_waitcnt lgkmcnt(0)
    v_mfma_f32_32x32x16_bf16 v[128:143], v[16:19], v[32:35], v[128:143]
    s_add_u32 m0, s47, 0
    s_add_u32 s48, s44, 229376
    buffer_load_dwordx4 v3, s[16:19], s48 offen lds
    buffer_load_dwordx4 v6, s[20:23], s48 offen offset:1024 lds
    v_mfma_f32_32x32x16_bf16 v[144:159], v[16:19], v[36:39], v[144:159]
    ds_read_b128 v[56:59], v113 offset:0
    ds_read_b128 v[60:63], v113 offset:32768
    s_waitcnt vmcnt(6)
    ds_read_b64_tr_b16 v[40:41], v4 offset:2048
    v_mfma_f32_32x32x16_bf16 v[160:175], v[20:23], v[32:35], v[160:175]
    ds_read_b64_tr_b16 v[42:43], v4 offset:2304
    ds_read_b64_tr_b16 v[44:45], v4 offset:3072
    ds_read_b64_tr_b16 v[46:47], v4 offset:3328
    v_mfma_f32_32x32x16_bf16 v[176:191], v[20:23], v[36:39], v[176:191]
    s_waitcnt lgkmcnt(0)
    v_mfma_f32_32x32x16_bf16 v[128:143], v[40:43], v[56:59], v[128:143]
    s_add_u32 m0, s47, 2048
    s_add_u32 s48, s44, 286720
    buffer_load_dwordx4 v3, s[16:19], s48 offen lds
    buffer_load_dwordx4 v6, s[20:23], s48 offen offset:1024 lds
    v_mfma_f32_32x32x16_bf16 v[144:159], v[40:43], v[60:63], v[144:159]
    ds_read_b128 v[32:35], v114 offset:0
    ds_read_b128 v[36:39], v114 offset:32768
    s_waitcnt vmcnt(6)
    ds_read_b64_tr_b16 v[16:17], v4 offset:4096
    v_mfma_f32_32x32x16_bf16 v[160:175], v[44:47], v[56:59], v[160:175]
    ds_read_b64_tr_b16 v[18:19], v4 offset:4352
    ds_read_b64_tr_b16 v[20:21], v4 offset:5120
    ds_read_b64_tr_b16 v[22:23], v4 offset:5376
    v_mfma_f32_32x32x16_bf16 v[176:191], v[44:47], v[60:63], v[176:191]
    s_call_b64 s[60:61], kf_merge
    s_cmp_ge_u32 s53, 57344
    s_cselect_b32 s53, 0, s53
    s_add_u32 s40, s50, s53
    s_add_u32 s53, s53, 8192
    buffer_load_dword v116, v118, s[24:27], s40 offen
    s_waitcnt lgkmcnt(0)
    v_mfma_f32_32x32x16_bf16 v[128:143], v[16:19], v[32:35], v[128:143]
    s_add_u32 m0, s47, 4096
    s_add_u32 s48, s44, 344064
    buffer_load_dwordx4 v3, s[16:19], s48 offen lds
    buffer_load_dwordx4 v6, s[20:23], s48 offen offset:1024 lds
    v_mfma_f32_32x32x16_bf16 v[144:159], v[16:19], v[36:39], v[144:159]
    ds_read_b128 v[56:59], v115 offset:0
    ds_read_b128 v[60:63], v115 offset:32768
    s_waitcnt vmcnt(6)
    ds_read_b64_tr_b16 v[40:41], v4 offset:6144
    v_mfma_f32_32x32x16_bf16 v[160:175], v[20:23], v[32:35], v[160:175]
    ds_read_b64_tr_b16 v[42:43], v4 offset:6400
    ds_read_b64_tr_b16 v[44:45], v4 offset:7168
    ds_read_b64_tr_b16 v[46:47], v4 offset:7424
    v_mfma_f32_32x32x16_bf16 v[176:191], v[20:23], v[36:39], v[176:191]
    s_waitcnt lgkmcnt(0)
    v_mfma_f32_32x32x16_bf16 v[128:143], v[40:43], v[56:59], v[128:143]
    s_add_u32 m0, s47, 6144
    s_add_u32 s48, s44, 401408
    buffer_load_dwordx4 v3, s[16:19], s48 offen lds
    buffer_load_dwordx4 v6, s[20:23], s48 offen offset:1024 lds
    v_mfma_f32_32x32x16_bf16 v[144:159], v[40:43], v[60:63], v[144:159]
    ds_read_b128 v[32:35], v112 offset:4096
    ds_read_b128 v[36:39], v112 offset:36864
    s_waitcnt vmcnt(6)
    ds_read_b64_tr_b16 v[16:17], v4 offset:0
    v_mfma_f32_32x32x16_bf16 v[160:175], v[44:47], v[56:59], v[160:175]
    ds_read_b64_tr_b16 v[18:19], v4 offset:256
    ds_read_b64_tr_b16 v[20:21], v4 offset:1024
    ds_read_b64_tr_b16 v[22:23], v4 offset:1280
    v_mfma_f32_32x32x16_bf16 v[176:191], v[44:47], v[60:63], v[176:191]
    s_call_b64 s[60:61], kf_merge
    s_cmp_ge_u32 s53, 57344
    s_cselect_b32 s53, 0, s53
    s_add_u32 s40, s50, s53
    s_add_u32 s53, s53, 8192
    buffer_load_dword v116, v118, s[24:27], s40 offen
    s_waitcnt lgkmcnt(0)
    v_mfma_f32_32x32x16_bf16 v[128:143], v[16:19], v[32:35], v[128:143]
    s_add_u32 m0, s47, 0
    s_add_u32 s48, s45, 0
    buffer_load_dwordx4 v3, s[16:19], s48 offen lds
    buffer_load_dwordx4 v6, s[20:23], s48 offen offset:1024 lds
    v_mfma_f32_32x32x16_bf16 v[144:159], v[16:19], v[36:39], v[144:159]
    ds_read_b128 v[56:59], v113 offset:4096
    ds_read_b128 v[60:63], v113 offset:36864
    s_waitcnt vmcnt(6)
    ds_read_b64_tr_b16 v[40:41], v4 offset:2048
    v_mfma_f32_32x32x16_bf16 v[160:175], v[20:23], v[32:35], v[160:175]
    ds_read_b64_tr_b16 v[42:43], v4 offset:2304
    ds_read_b64_tr_b16 v[44:45], v4 offset:3072
    ds_read_b64_tr_b16 v[46:47], v4 offset:3328
    v_mfma_f32_32x32x16_bf16 v[176:191], v[20:23], v[36:39], v[176:191]
    s_waitcnt lgkmcnt(0)
    v_mfma_f32_32x32x16_bf16 v[128:143], v[40:43], v[56:59], v[128:143]
    s_add_u32 m0, s47, 2048
    s_add_u32 s48, s45, 57344
    buffer_load_dwordx4 v3, s[16:19], s48 offen lds
    buffer_load_dwordx4 v6, s[20:23], s48 offen offset:1024 lds
    v_mfma_f32_32x32x16_bf16 v[144:159], v[40:43], v[60:63], v[144:159]
    ds_read_b128 v[32:35], v114 offset:4096
    ds_read_b128 v[36:39], v114 offset:36864
    s_waitcnt vmcnt(6)
    ds_read_b64_tr_b16 v[16:17], v4 offset:4096
    v_mfma_f32_32x32x16_bf16 v[160:175], v[44:47], v[56:59], v[160:175]
    ds_read_b64_tr_b16 v[18:19], v4 offset:4352
    ds_read_b64_tr_b16 v[20:21], v4 offset:5120
    ds_read_b64_tr_b16 v[22:23], v4 offset:5376
    v_mfma_f32_32x32x16_bf16 v[176:191], v[44:47], v[60:63], v[176:191]
    s_call_b64 s[60:61], kf_merge
    s_cmp_ge_u32 s53, 57344
    s_cselect_b32 s53, 0, s53
    s_add_u32 s40, s50, s53
    s_add_u32 s53, s53, 8192
    buffer_load_dword v116, v118, s[24:27], s40 offen
    s_waitcnt lgkmcnt(0)
    v_mfma_f32_32x32x16_bf16 v[128:143], v[16:19], v[32:35], v[128:143]
    s_add_u32 m0, s47, 4096
    s_add_u32 s48, s45, 114688
    buffer_load_dwordx4 v3, s[16:19], s48 offen lds
    buffer_load_dwordx4 v6, s[20:23], s48 offen offset:1024 lds
    v_mfma_f32_32x32x16_bf16 v[144:159], v[16:19], v[36:39], v[144:159]
    ds_read_b128 v[56:59], v115 offset:4096
    ds_read_b128 v[60:63], v115 offset:36864
    s_waitcnt vmcnt(6)
    ds_read_b64_tr_b16 v[40:41], v4 offset:6144
    v_mfma_f32_32x32x16_bf16 v[160:175], v[20:23], v[32:35], v[160:175]
    ds_read_b64_tr_b16 v[42:43], v4 offset:6400
    ds_read_b64_tr_b16 v[44:45], v4 offset:7168
    ds_read_b64_tr_b16 v[46:47], v4 offset:7424
    v_mfma_f32_32x32x16_bf16 v[176:191], v[20:23], v[36:39], v[176:191]
    s_waitcnt lgkmcnt(0)
    s_cmp_eq_u32 s49, 1
    s_cselect_b32 s40, 4294942720, s52
    s_setprio 3
    v_add_u32 v112, s40, v112
    v_add_u32 v113, s40, v113
    v_add_u32 v114, s40, v114
    v_add_u32 v115, s40, v115
    s_setprio 0
    v_mfma_f32_32x32x16_bf16 v[128:143], v[40:43], v[56:59], v[128:143]
    s_add_u32 m0, s47, 6144
    s_add_u32 s48, s45, 172032
    buffer_load_dwordx4 v3, s[16:19], s48 offen lds
    buffer_load_dwordx4 v6, s[20:23], s48 offen offset:1024 lds
    v_mfma_f32_32x32x16_bf16 v[144:159], v[40:43], v[60:63], v[144:159]
    ds_read_b128 v[32:35], v112 offset:0
    ds_read_b128 v[36:39], v112 offset:32768
    s_waitcnt vmcnt(6)
    ds_read_b64_tr_b16 v[16:17], v4 offset:0
    v_mfma_f32_32x32x16_bf16 v[160:175], v[44:47], v[56:59], v[160:175]
    ds_read_b64_tr_b16 v[18:19], v4 offset:256
    ds_read_b64_tr_b16 v[20:21], v4 offset:1024
    ds_read_b64_tr_b16 v[22:23], v4 offset:1280
    v_mfma_f32_32x32x16_bf16 v[176:191], v[44:47], v[60:63], v[176:191]
    s_call_b64 s[60:61], kf_merge
    s_add_u32 s40, s51, 0
    buffer_load_dword v116, v118, s[96:99], s40 offen
    s_waitcnt lgkmcnt(0)
    v_mfma_f32_32x32x16_bf16 v[128:143], v[16:19], v[32:35], v[128:143]
    s_add_u32 m0, s47, 0
    s_add_u32 s48, s45, 229376
    buffer_load_dwordx4 v3, s[16:19], s48 offen lds
    buffer_load_dwordx4 v6, s[20:23], s48 offen offset:1024 lds
    v_mfma_f32_32x32x16_bf16 v[144:159], v[16:19], v[36:39], v[144:159]
    ds_read_b128 v[56:59], v113 offset:0
    ds_read_b128 v[60:63], v113 offset:32768
    s_waitcnt vmcnt(6)
    ds_read_b64_tr_b16 v[40:41], v4 offset:2048
    v_mfma_f32_32x32x16_bf16 v[160:175], v[20:23], v[32:35], v[160:175]
    ds_read_b64_tr_b16 v[42:43], v4 offset:2304
    ds_read_b64_tr_b16 v[44:45], v4 offset:3072
    ds_read_b64_tr_b16 v[46:47], v4 offset:3328
    v_mfma_f32_32x32x16_bf16 v[176:191], v[20:23], v[36:39], v[176:191]
    s_waitcnt lgkmcnt(0)
    v_mfma_f32_32x32x16_bf16 v[128:143], v[40:43], v[56:59], v[128:143]
    s_add_u32 m0, s47, 2048
    s_add_u32 s48, s45, 286720
    buffer_load_dwordx4 v3, s[16:19], s48 offen lds
    buffer_load_dwordx4 v6, s[20:23], s48 offen offset:1024 lds
    v_mfma_f32_32x32x16_bf16 v[144:159], v[40:43], v[60:63], v[144:159]
    ds_read_b128 v[32:35], v114 offset:0
    ds_read_b128 v[36:39], v114 offset:32768
    s_waitcnt vmcnt(6)
    ds_read_b64_tr_b16 v[16:17], v4 offset:4096
    v_mfma_f32_32x32x16_bf16 v[160:175], v[44:47], v[56:59], v[160:175]
    ds_read_b64_tr_b16 v[18:19], v4 offset:4352
    ds_read_b64_tr_b16 v[20:21], v4 offset:5120
    ds_read_b64_tr_b16 v[22:23], v4 offset:5376
    v_mfma_f32_32x32x16_bf16 v[176:191], v[44:47], v[60:63], v[176:191]
    s_call_b64 s[60:61], kf_merge
    s_add_u32 s40, s51, 8192
    buffer_load_dword v116, v118, s[96:99], s40 offen
    s_waitcnt lgkmcnt(0)
    v_mfma_f32_32x32x16_bf16 v[128:143], v[16:19], v[32:35], v[128:143]
    s_add_u32 m0, s47, 4096
    s_add_u32 s48, s45, 344064
    buffer_load_dwordx4 v3, s[16:19], s48 offen lds
    buffer_load_dwordx4 v6, s[20:23], s48 offen offset:1024 lds
    v_mfma_f32_32x32x16_bf16 v[144:159], v[16:19], v[36:39], v[144:159]
    ds_read_b128 v[56:59], v115 offset:0
    ds_read_b128 v[60:63], v115 offset:32768
    s_waitcnt vmcnt(6)
    ds_read_b64_tr_b16 v[40:41], v4 offset:6144
    v_mfma_f32_32x32x16_bf16 v[160:175], v[20:23], v[32:35], v[160:175]
    ds_read_b64_tr_b16 v[42:43], v4 offset:6400
    ds_read_b64_tr_b16 v[44:45], v4 offset:7168
    ds_read_b64_tr_b16 v[46:47], v4 offset:7424
    v_mfma_f32_32x32x16_bf16 v[176:191], v[20:23], v[36:39], v[176:191]
    s_waitcnt lgkmcnt(0)
    v_mfma_f32_32x32x16_bf16 v[128:143], v[40:43], v[56:59], v[128:143]
    s_add_u32 m0, s47, 6144
    s_add_u32 s48, s45, 401408
    buffer_load_dwordx4 v3, s[16:19], s48 offen lds
    buffer_load_dwordx4 v6, s[20:23], s48 offen offset:1024 lds
    v_mfma_f32_32x32x16_bf16 v[144:159], v[40:43], v[60:63], v[144:159]
    ds_read_b128 v[32:35], v112 offset:4096
    ds_read_b128 v[36:39], v112 offset:36864
    s_waitcnt vmcnt(6)
    ds_read_b64_tr_b16 v[16:17], v4 offset:0
    v_mfma_f32_32x32x16_bf16 v[160:175], v[44:47], v[56:59], v[160:175]
    ds_read_b64_tr_b16 v[18:19], v4 offset:256
    ds_read_b64_tr_b16 v[20:21], v4 offset:1024
    ds_read_b64_tr_b16 v[22:23], v4 offset:1280
    v_mfma_f32_32x32x16_bf16 v[176:191], v[44:47], v[60:63], v[176:191]
    s_call_b64 s[60:61], kf_merge
    s_waitcnt lgkmcnt(0)
    v_mfma_f32_32x32x16_bf16 v[128:143], v[16:19], v[32:35], v[128:143]
    v_mfma_f32_32x32x16_bf16 v[144:159], v[16:19], v[36:39], v[144:159]
    ds_read_b128 v[56:59], v113 offset:4096
    ds_read_b128 v[60:63], v113 offset:36864
    s_waitcnt vmcnt(4)
    ds_read_b64_tr_b16 v[40:41], v4 offset:2048
    v_mfma_f32_32x32x16_bf16 v[160:175], v[20:23], v[32:35], v[160:175]
    ds_read_b64_tr_b16 v[42:43], v4 offset:2304
    ds_read_b64_tr_b16 v[44:45], v4 offset:3072
    ds_read_b64_tr_b16 v[46:47], v4 offset:3328
    v_mfma_f32_32x32x16_bf16 v[176:191], v[20:23], v[36:39], v[176:191]
    s_waitcnt lgkmcnt(0)
    v_mfma_f32_32x32x16_bf16 v[128:143], v[40:43], v[56:59], v[128:143]
    v_mfma_f32_32x32x16_bf16 v[144:159], v[40:43], v[60:63], v[144:159]
    ds_read_b128 v[32:35], v114 offset:4096
    ds_read_b128 v[36:39], v114 offset:36864
    s_waitcnt vmcnt(2)
    ds_read_b64_tr_b16 v[16:17], v4 offset:4096
    v_mfma_f32_32x32x16_bf16 v[160:175], v[44:47], v[56:59], v[160:175]
    ds_read_b64_tr_b16 v[18:19], v4 offset:4352
    ds_read_b64_tr_b16 v[20:21], v4 offset:5120
    ds_read_b64_tr_b16 v[22:23], v4 offset:5376
    v_mfma_f32_32x32x16_bf16 v[176:191], v[44:47], v[60:63], v[176:191]
    s_call_b64 s[60:61], kf_merge
    s_waitcnt lgkmcnt(0)
    v_mfma_f32_32x32x16_bf16 v[128:143], v[16:19], v[32:35], v[128:143]
    v_mfma_f32_32x32x16_bf16 v[144:159], v[16:19], v[36:39], v[144:159]
    ds_read_b128 v[56:59], v115 offset:4096
    ds_read_b128 v[60:63], v115 offset:36864
    s_waitcnt vmcnt(0)
    ds_read_b64_tr_b16 v[40:41], v4 offset:6144
    v_mfma_f32_32x32x16_bf16 v[160:175], v[20:23], v[32:35], v[160:175]
    ds_read_b64_tr_b16 v[42:43], v4 offset:6400
    ds_read_b64_tr_b16 v[44:45], v4 offset:7168
    ds_read_b64_tr_b16 v[46:47], v4 offset:7424
    v_mfma_f32_32x32x16_bf16 v[176:191], v[20:23], v[36:39], v[176:191]
    s_waitcnt lgkmcnt(0)
    v_mfma_f32_32x32x16_bf16 v[128:143], v[40:43], v[56:59], v[128:143]
    v_mfma_f32_32x32x16_bf16 v[144:159], v[40:43], v[60:63], v[144:159]
    v_mfma_f32_32x32x16_bf16 v[160:175], v[44:47], v[56:59], v[160:175]
    v_mfma_f32_32x32x16_bf16 v[176:191], v[44:47], v[60:63], v[176:191]
    s_call_b64 s[60:61], kf_merge
    s_setprio 3
    s_nop 7
    s_lshr_b32 s40, s46, 5
    s_mul_i32 s41, s38, 224
    s_add_u32 s40, s40, s41
    s_lshl_b32 s40, s40, 10
    s_add_u32 s40, s40, 11010048
    s_add_u32 s41, s40, 114688
    v_max_f32 v128, 0, v128
    v_max_f32 v129, 0, v129
    v_max_f32 v130, 0, v130
    v_max_f32 v131, 0, v131
    v_max_f32 v132, 0, v132
    v_max_f32 v133, 0, v133
    v_max_f32 v134, 0, v134
    v_max_f32 v135, 0, v135
    v_max_f32 v136, 0, v136
    v_max_f32 v137, 0, v137
    v_max_f32 v138, 0, v138
    v_max_f32 v139, 0, v139
    v_max_f32 v140, 0, v140
    v_max_f32 v141, 0, v141
    v_max_f32 v142, 0, v142
    v_max_f32 v143, 0, v143
    v_pk_mul_f32 v[128:129], v[128:129], v[160:161]
    v_pk_mul_f32 v[130:131], v[130:131], v[162:163]
    v_pk_mul_f32 v[132:133], v[132:133], v[164:165]
    v_pk_mul_f32 v[134:135], v[134:135], v[166:167]
    v_pk_mul_f32 v[136:137], v[136:137], v[168:169]
    v_pk_mul_f32 v[138:139], v[138:139], v[170:171]
    v_pk_mul_f32 v[140:141], v[140:141], v[172:173]
    v_pk_mul_f32 v[142:143], v[142:143], v[174:175]
    v_cvt_pk_bf16_f32 v160, v128, v129
    v_cvt_pk_bf16_f32 v161, v130, v131
    v_cvt_pk_bf16_f32 v162, v132, v133
    v_cvt_pk_bf16_f32 v163, v134, v135
    v_cvt_pk_bf16_f32 v164, v136, v137
    v_cvt_pk_bf16_f32 v165, v138, v139
    v_cvt_pk_bf16_f32 v166, v140, v141
    v_cvt_pk_bf16_f32 v167, v142, v143
    buffer_store_dwordx4 v[160:163], v1, s[28:31], s40 offen offset:0 sc1
    buffer_store_dwordx4 v[164:167], v1, s[28:31], s40 offen offset:1024 sc1
    v_max_f32 v144, 0, v144
    v_max_f32 v145, 0, v145
    v_max_f32 v146, 0, v146
    v_max_f32 v147, 0, v147
    v_max_f32 v148, 0, v148
    v_max_f32 v149, 0, v149
    v_max_f32 v150, 0, v150
    v_max_f32 v151, 0, v151
    v_max_f32 v152, 0, v152
    v_max_f32 v153, 0, v153
    v_max_f32 v154, 0, v154
    v_max_f32 v155, 0, v155
    v_max_f32 v156, 0, v156
    v_max_f32 v157, 0, v157
    v_max_f32 v158, 0, v158
    v_max_f32 v159, 0, v159
    v_pk_mul_f32 v[144:145], v[144:145], v[176:177]
    v_pk_mul_f32 v[146:147], v[146:147], v[178:179]
    v_pk_mul_f32 v[148:149], v[148:149], v[180:181]
    v_pk_mul_f32 v[150:151], v[150:151], v[182:183]
    v_pk_mul_f32 v[152:153], v[152:153], v[184:185]
    v_pk_mul_f32 v[154:155], v[154:155], v[186:187]
    v_pk_mul_f32 v[156:157], v[156:157], v[188:189]
    v_pk_mul_f32 v[158:159], v[158:159], v[190:191]
    v_cvt_pk_bf16_f32 v176, v144, v145
    v_cvt_pk_bf16_f32 v177, v146, v147
    v_cvt_pk_bf16_f32 v178, v148, v149
    v_cvt_pk_bf16_f32 v179, v150, v151
    v_cvt_pk_bf16_f32 v180, v152, v153
    v_cvt_pk_bf16_f32 v181, v154, v155
    v_cvt_pk_bf16_f32 v182, v156, v157
    v_cvt_pk_bf16_f32 v183, v158, v159
    buffer_store_dwordx4 v[176:179], v1, s[28:31], s41 offen offset:0 sc1
    buffer_store_dwordx4 v[180:183], v1, s[28:31], s41 offen offset:1024 sc1
kf_g2:
    s_mov_b32 s16, s12
    s_and_b32 s17, s13, 0xffff
    s_mov_b32 s18, 256
    s_mov_b32 s19, 0x20000
    v_mov_b32 v118, 0
    buffer_load_dwordx2 v[14:15], v118, s[16:19], 0 offen sc1
    s_mov_b32 s24, s68
    s_and_b32 s25, s69, 0xffff
    s_mov_b32 s26, 1835008
    s_mov_b32 s27, 0x20000
    v_lshrrev_b32 v10, 3, v2
    v_and_b32 v11, 2, v10
    v_lshlrev_b32 v11, 1, v11
    v_and_b32 v12, 7, v2
    v_xor_b32 v11, v11, v12
    v_lshlrev_b32 v11, 4, v11
    v_lshl_add_u32 v122, v10, 10, v11
    v_lshrrev_b32 v10, 5, v2
    v_bfe_u32 v11, v2, 2, 2
    v_lshl_add_u32 v10, v10, 2, v11
    v_lshlrev_b32 v10, 7, v10
    v_bfe_u32 v12, v2, 4, 1
    v_lshl_add_u32 v10, v12, 5, v10
    v_and_b32 v12, 3, v2
    v_lshl_add_u32 v10, v12, 3, v10
    v_add_u32 v10, s47, v10
    v_lshrrev_b32 v11, 1, v11
    v_lshlrev_b32 v11, 6, v11
    v_add_u32 v4, v10, v11
    v_xor_b32 v11, 64, v11
    v_add_u32 v5, v10, v11
    v_add_u32 v123, 7168, v122
    s_xor_b32 s42, s35, 1
    s_and_b32 s40, s42, 1
    s_mul_i32 s40, s40, 114688
    v_add_u32 v119, s40, v1
    s_sub_u32 s40, 114688, s40
    v_add_u32 v7, s40, v1
    s_lshr_b32 s40, s42, 1
    s_lshl_b32 s40, s40, 6
    v_xor_b32 v4, s40, v4
    v_xor_b32 v5, s40, v5
    s_lshl_b32 s57, s34, 7
    s_mul_i32 s50, s33, 229376
    s_add_u32 s50, s50, 11010048
    s_add_u32 s51, s50, 114688
    s_add_u32 s54, s57, 1835008
    s_mul_i32 s40, s34, 7
    s_lshr_b32 s40, s40, 1
    s_and_b32 s41, s33, 3
    s_mul_i32 s41, s41, 7
    s_add_u32 s40, s40, s41
    s_sub_u32 s41, s40, 28
    s_cmp_ge_u32 s40, 28
    s_cselect_b32 s40, s41, s40
    s_mul_i32 s41, s35, 28
    s_add_u32 s40, s40, s41
    s_lshl_b32 s56, s40, 14
    s_add_u32 s56, s56, s57
    s_lshl_b32 s49, s40, 10
    s_add_u32 s49, s49, s50
    s_lshl_b32 s43, s35, 14
    s_sub_u32 s40, s43, s47
    v_add_u32 v124, s40, v4
    v_add_u32 v125, s40, v5
    s_add_u32 m0, s47, 0
    s_cmp_eq_u32 s56, s54
    s_cselect_b32 s56, s57, s56
    buffer_load_dwordx4 v122, s[24:27], s56 offen lds
    buffer_load_dwordx4 v123, s[24:27], s56 offen offset:1024 lds
    s_add_u32 s56, s56, 16384
    s_add_u32 m0, s47, 2048
    s_cmp_eq_u32 s56, s54
    s_cselect_b32 s56, s57, s56
    buffer_load_dwordx4 v122, s[24:27], s56 offen lds
    buffer_load_dwordx4 v123, s[24:27], s56 offen offset:1024 lds
    s_add_u32 s56, s56, 16384
    s_add_u32 m0, s47, 4096
    s_cmp_eq_u32 s56, s54
    s_cselect_b32 s56, s57, s56
    buffer_load_dwordx4 v122, s[24:27], s56 offen lds
    buffer_load_dwordx4 v123, s[24:27], s56 offen offset:1024 lds
    s_add_u32 s56, s56, 16384
    s_add_u32 m0, s47, 6144
    s_cmp_eq_u32 s56, s54
    s_cselect_b32 s56, s57, s56
    buffer_load_dwordx4 v122, s[24:27], s56 offen lds
    buffer_load_dwordx4 v123, s[24:27], s56 offen offset:1024 lds
    s_add_u32 s56, s56, 16384
    s_call_b64 s[60:61], kf_merge
    s_waitcnt vmcnt(8)
    s_setprio 3
7:
    v_readfirstlane_b32 s74, v14
    v_readfirstlane_b32 s75, v15
    s_cmp_lg_u32 s74, 0
    s_cbranch_scc1 8f
    buffer_load_dwordx2 v[14:15], v118, s[16:19], 0 offen sc1
    s_waitcnt vmcnt(0)
    s_branch 7b
8:
    v_mov_b32 v8, 100384
    v_mov_b32 v9, 1
    s_mov_b64 exec, 1
    ds_add_rtn_u32 v9, v8, v9
    s_mov_b64 exec, -1
    s_waitcnt lgkmcnt(0)
    v_readfirstlane_b32 s40, v9
    s_nop 0
    s_and_b32 s40, s40, 15
    s_cmp_eq_u32 s40, 3
    s_cbranch_scc0 4f
    s_lshl_b32 s40, s38, 8
    s_lshl_b32 s41, s39, 3
    s_add_u32 s40, s40, s41
    s_add_u32 s40, s40, 4505600
    s_mov_b64 exec, 1
    buffer_store_dwordx2 v[14:15], v118, s[28:31], s40 offen sc1
    s_mov_b64 exec, -1
4:
    s_mov_b32 s20, s72
    s_and_b32 s21, s73, 0xffff
    s_mov_b32 s22, 524288
    s_mov_b32 s23, 0x20000
    v_lshlrev_b32 v10, 7, v2
    s_lshr_b32 s41, s2, 3
    s_mul_i32 s46, s41, 57344
    s_lshl_b32 s41, s41, 14
    s_mov_b32 s55, 0
2:
    ds_read_b32 v9, v8
    s_waitcnt lgkmcnt(0)
    s_setprio 3
    v_readfirstlane_b32 s40, v9
    s_nop 0
    s_cmp_ge_u32 s40, 4
    s_cbranch_scc1 3f
    s_cmp_lg_u32 s35, 3
    s_cbranch_scc1 5f
    s_cmp_ge_u32 s55, 0
    s_cbranch_scc1 5f
    s_cmp_ge_u32 s55, 7
    s_cbranch_scc1 6f
    buffer_load_dword v116, v10, s[24:27], s46 offen
    s_add_u32 s46, s46, 8192
    s_branch 7f
6:
    buffer_load_dword v116, v10, s[20:23], s41 offen
    s_add_u32 s41, s41, 8192
7:
    s_add_u32 s55, s55, 1
5:
    s_call_b64 s[60:61], kf_merge
    s_sleep 6
    s_branch 2b
3:
    s_lshl_b32 s46, s35, 17
    s_add_u32 s46, s46, s57
    s_add_u32 m0, s43, 0
    s_cmp_eq_u32 s56, s54
    s_cselect_b32 s56, s57, s56
    buffer_load_dwordx4 v122, s[24:27], s56 offen lds
    buffer_load_dwordx4 v123, s[24:27], s56 offen offset:1024 lds
    s_add_u32 s56, s56, 16384
    s_add_u32 m0, s43, 2048
    s_cmp_eq_u32 s56, s54
    s_cselect_b32 s56, s57, s56
    buffer_load_dwordx4 v122, s[24:27], s56 offen lds
    buffer_load_dwordx4 v123, s[24:27], s56 offen offset:1024 lds
    s_add_u32 s56, s56, 16384
    s_add_u32 m0, s43, 4096
    s_cmp_eq_u32 s56, s54
    s_cselect_b32 s56, s57, s56
    buffer_load_dwordx4 v122, s[24:27], s56 offen lds
    buffer_load_dwordx4 v123, s[24:27], s56 offen offset:1024 lds
    s_add_u32 s56, s56, 16384
    s_add_u32 m0, s43, 6144
    s_cmp_eq_u32 s56, s54
    s_cselect_b32 s56, s57, s56
    buffer_load_dwordx4 v122, s[24:27], s56 offen lds
    buffer_load_dwordx4 v123, s[24:27], s56 offen offset:1024 lds
    s_add_u32 s56, s56, 16384
    s_add_u32 m0, s43, 8192
    s_cmp_eq_u32 s56, s54
    s_cselect_b32 s56, s57, s56
    buffer_load_dwordx4 v122, s[24:27], s56 offen lds
    buffer_load_dwordx4 v123, s[24:27], s56 offen offset:1024 lds
    s_add_u32 s56, s56, 16384
    s_add_u32 m0, s43, 10240
    s_cmp_eq_u32 s56, s54
    s_cselect_b32 s56, s57, s56
    buffer_load_dwordx4 v122, s[24:27], s56 offen lds
    buffer_load_dwordx4 v123, s[24:27], s56 offen offset:1024 lds
    s_add_u32 s56, s56, 16384
    s_add_u32 m0, s43, 12288
    s_cmp_eq_u32 s56, s54
    s_cselect_b32 s56, s57, s56
    buffer_load_dwordx4 v122, s[24:27], s56 offen lds
    buffer_load_dwordx4 v123, s[24:27], s56 offen offset:1024 lds
    s_add_u32 s56, s56, 16384
    s_add_u32 m0, s43, 14336
    s_cmp_eq_u32 s56, s54
    s_cselect_b32 s56, s57, s56
    buffer_load_dwordx4 v122, s[24:27], s56 offen lds
    buffer_load_dwordx4 v123, s[24:27], s56 offen offset:1024 lds
    s_add_u32 s56, s56, 16384
    s_lshl_b32 s41, s33, 8
    s_add_u32 s41, s41, 4505600
    v_and_b32 v12, 7, v2
    v_lshlrev_b32 v12, 3, v12
5:
    s_call_b64 s[60:61], kf_merge
    buffer_load_dwordx2 v[10:11], v12, s[28:31], s41 offen sc1
    s_waitcnt vmcnt(0)
    s_setprio 3
    v_xor_b32 v10, s74, v10
    v_xor_b32 v11, s75, v11
    v_or_b32 v10, v10, v11
    v_cmp_ne_u32 vcc, 0, v10
    s_nop 0
    s_cbranch_vccz 6f
    s_sleep 4
    s_branch 5b
6:
    s_setprio 0
    buffer_load_dwordx4 v[192:195], v119, s[28:31], s49 offen sc1
    buffer_load_dwordx4 v[196:199], v7, s[28:31], s49 offen sc1
    s_add_u32 s49, s49, 1024
    s_cmp_eq_u32 s49, s51
    s_cselect_b32 s49, s50, s49
    buffer_load_dwordx4 v[200:203], v119, s[28:31], s49 offen sc1
    buffer_load_dwordx4 v[204:207], v7, s[28:31], s49 offen sc1
    s_add_u32 s49, s49, 1024
    s_cmp_eq_u32 s49, s51
    s_cselect_b32 s49, s50, s49
    buffer_load_dwordx4 v[208:211], v119, s[28:31], s49 offen sc1
    buffer_load_dwordx4 v[212:215], v7, s[28:31], s49 offen sc1
    s_add_u32 s49, s49, 1024
    s_cmp_eq_u32 s49, s51
    s_cselect_b32 s49, s50, s49
    buffer_load_dwordx4 v[216:219], v119, s[28:31], s49 offen sc1
    buffer_load_dwordx4 v[220:223], v7, s[28:31], s49 offen sc1
    s_add_u32 s49, s49, 1024
    s_cmp_eq_u32 s49, s51
    s_cselect_b32 s49, s50, s49
    buffer_load_dwordx4 v[224:227], v119, s[28:31], s49 offen sc1
    buffer_load_dwordx4 v[228:231], v7, s[28:31], s49 offen sc1
    s_add_u32 s49, s49, 1024
    s_cmp_eq_u32 s49, s51
    s_cselect_b32 s49, s50, s49
    buffer_load_dwordx4 v[232:235], v119, s[28:31], s49 offen sc1
    buffer_load_dwordx4 v[236:239], v7, s[28:31], s49 offen sc1
    s_add_u32 s49, s49, 1024
    s_cmp_eq_u32 s49, s51
    s_cselect_b32 s49, s50, s49
    buffer_load_dwordx4 v[240:243], v119, s[28:31], s49 offen sc1
    buffer_load_dwordx4 v[244:247], v7, s[28:31], s49 offen sc1
    s_add_u32 s49, s49, 1024
    s_cmp_eq_u32 s49, s51
    s_cselect_b32 s49, s50, s49
    buffer_load_dwordx4 v[248:251], v119, s[28:31], s49 offen sc1
    buffer_load_dwordx4 v[252:255], v7, s[28:31], s49 offen sc1
    s_add_u32 s49, s49, 1024
    s_cmp_eq_u32 s49, s51
    s_cselect_b32 s49, s50, s49
    s_call_b64 s[60:61], kf_merge
    s_lshl_b32 s44, s33, 16
    s_and_b32 s40, s42, 1
    s_lshl_b32 s40, s40, 15
    s_add_u32 s44, s44, s40
    s_add_u32 s45, s44, 4718592
    ds_read_b64_tr_b16 v[16:17], v4 offset:0
    ds_read_b64_tr_b16 v[18:19], v4 offset:1024
    ds_read_b64_tr_b16 v[20:21], v5 offset:0
    ds_read_b64_tr_b16 v[22:23], v5 offset:1024
    s_waitcnt lgkmcnt(0) vmcnt(14)
    v_mfma_f32_32x32x16_bf16 v[128:143], v[16:19], v[192:195], 0
    ds_read_b64_tr_b16 v[40:41], v4 offset:2048
    ds_read_b64_tr_b16 v[42:43], v4 offset:3072
    ds_read_b64_tr_b16 v[44:45], v5 offset:2048
    ds_read_b64_tr_b16 v[46:47], v5 offset:3072
    v_mfma_f32_32x32x16_bf16 v[144:159], v[16:19], v[196:199], 0
    s_add_u32 m0, s47, 0
    s_cmp_eq_u32 s56, s54
    s_cselect_b32 s56, s57, s56
    buffer_load_dwordx4 v122, s[24:27], s56 offen lds
    v_mfma_f32_32x32x16_bf16 v[160:175], v[20:23], v[192:195], 0
    buffer_load_dwordx4 v123, s[24:27], s56 offen offset:1024 lds
    s_add_u32 s56, s56, 16384
    v_mfma_f32_32x32x16_bf16 v[176:191], v[20:23], v[196:199], 0
    buffer_load_dwordx4 v[192:195], v119, s[28:31], s49 offen sc1
    buffer_load_dwordx4 v[196:199], v7, s[28:31], s49 offen sc1
    s_add_u32 s49, s49, 1024
    s_cmp_eq_u32 s49, s51
    s_cselect_b32 s49, s50, s49
    s_waitcnt lgkmcnt(0) vmcnt(16)
    v_mfma_f32_32x32x16_bf16 v[128:143], v[40:43], v[200:203], v[128:143]
    ds_read_b64_tr_b16 v[16:17], v4 offset:4096
    ds_read_b64_tr_b16 v[18:19], v4 offset:5120
    ds_read_b64_tr_b16 v[20:21], v5 offset:4096
    ds_read_b64_tr_b16 v[22:23], v5 offset:5120
    v_mfma_f32_32x32x16_bf16 v[144:159], v[40:43], v[204:207], v[144:159]
    s_add_u32 m0, s47, 2048
    s_cmp_eq_u32 s56, s54
    s_cselect_b32 s56, s57, s56
    buffer_load_dwordx4 v122, s[24:27], s56 offen lds
    v_mfma_f32_32x32x16_bf16 v[160:175], v[44:47], v[200:203], v[160:175]
    buffer_load_dwordx4 v123, s[24:27], s56 offen offset:1024 lds
    s_add_u32 s56, s56, 16384
    v_mfma_f32_32x32x16_bf16 v[176:191], v[44:47], v[204:207], v[176:191]
    buffer_load_dwordx4 v[200:203], v119, s[28:31], s49 offen sc1
    buffer_load_dwordx4 v[204:207], v7, s[28:31], s49 offen sc1
    s_add_u32 s49, s49, 1024
    s_cmp_eq_u32 s49, s51
    s_cselect_b32 s49, s50, s49
    s_waitcnt lgkmcnt(0) vmcnt(18)
    v_mfma_f32_32x32x16_bf16 v[128:143], v[16:19], v[208:211], v[128:143]
    ds_read_b64_tr_b16 v[40:41], v4 offset:6144
    ds_read_b64_tr_b16 v[42:43], v4 offset:7168
    ds_read_b64_tr_b16 v[44:45], v5 offset:6144
    ds_read_b64_tr_b16 v[46:47], v5 offset:7168
    v_mfma_f32_32x32x16_bf16 v[144:159], v[16:19], v[212:215], v[144:159]
    s_add_u32 m0, s47, 4096
    s_cmp_eq_u32 s56, s54
    s_cselect_b32 s56, s57, s56
    buffer_load_dwordx4 v122, s[24:27], s56 offen lds
    v_mfma_f32_32x32x16_bf16 v[160:175], v[20:23], v[208:211], v[160:175]
    buffer_load_dwordx4 v123, s[24:27], s56 offen offset:1024 lds
    s_add_u32 s56, s56, 16384
    v_mfma_f32_32x32x16_bf16 v[176:191], v[20:23], v[212:215], v[176:191]
    buffer_load_dwordx4 v[208:211], v119, s[28:31], s49 offen sc1
    buffer_load_dwordx4 v[212:215], v7, s[28:31], s49 offen sc1
    s_add_u32 s49, s49, 1024
    s_cmp_eq_u32 s49, s51
    s_cselect_b32 s49, s50, s49
    s_waitcnt lgkmcnt(0) vmcnt(20)
    v_mfma_f32_32x32x16_bf16 v[128:143], v[40:43], v[216:219], v[128:143]
    ds_read_b64_tr_b16 v[16:17], v124 offset:0
    ds_read_b64_tr_b16 v[18:19], v124 offset:1024
    ds_read_b64_tr_b16 v[20:21], v125 offset:0
    ds_read_b64_tr_b16 v[22:23], v125 offset:1024
    v_mfma_f32_32x32x16_bf16 v[144:159], v[40:43], v[220:223], v[144:159]
    s_add_u32 m0, s47, 6144
    s_cmp_eq_u32 s56, s54
    s_cselect_b32 s56, s57, s56
    buffer_load_dwordx4 v122, s[24:27], s56 offen lds
    v_mfma_f32_32x32x16_bf16 v[160:175], v[44:47], v[216:219], v[160:175]
    buffer_load_dwordx4 v123, s[24:27], s56 offen offset:1024 lds
    s_add_u32 s56, s56, 16384
    v_mfma_f32_32x32x16_bf16 v[176:191], v[44:47], v[220:223], v[176:191]
    buffer_load_dwordx4 v[216:219], v119, s[28:31], s49 offen sc1
    buffer_load_dwordx4 v[220:223], v7, s[28:31], s49 offen sc1
    s_add_u32 s49, s49, 1024
    s_cmp_eq_u32 s49, s51
    s_cselect_b32 s49, s50, s49
    s_waitcnt lgkmcnt(0) vmcnt(22)
    v_mfma_f32_32x32x16_bf16 v[128:143], v[16:19], v[224:227], v[128:143]
    ds_read_b64_tr_b16 v[40:41], v124 offset:2048
    ds_read_b64_tr_b16 v[42:43], v124 offset:3072
    ds_read_b64_tr_b16 v[44:45], v125 offset:2048
    ds_read_b64_tr_b16 v[46:47], v125 offset:3072
    v_mfma_f32_32x32x16_bf16 v[144:159], v[16:19], v[228:231], v[144:159]
    s_add_u32 m0, s43, 0
    s_cmp_eq_u32 s56, s54
    s_cselect_b32 s56, s57, s56
    buffer_load_dwordx4 v122, s[24:27], s56 offen lds
    v_mfma_f32_32x32x16_bf16 v[160:175], v[20:23], v[224:227], v[160:175]
    buffer_load_dwordx4 v123, s[24:27], s56 offen offset:1024 lds
    s_add_u32 s56, s56, 16384
    v_mfma_f32_32x32x16_bf16 v[176:191], v[20:23], v[228:231], v[176:191]
    buffer_load_dwordx4 v[224:227], v119, s[28:31], s49 offen sc1
    buffer_load_dwordx4 v[228:231], v7, s[28:31], s49 offen sc1
    s_add_u32 s49, s49, 1024
    s_cmp_eq_u32 s49, s51
    s_cselect_b32 s49, s50, s49
    s_waitcnt lgkmcnt(0) vmcnt(24)
    v_mfma_f32_32x32x16_bf16 v[128:143], v[40:43], v[232:235], v[128:143]
    ds_read_b64_tr_b16 v[16:17], v124 offset:4096
    ds_read_b64_tr_b16 v[18:19], v124 offset:5120
    ds_read_b64_tr_b16 v[20:21], v125 offset:4096
    ds_read_b64_tr_b16 v[22:23], v125 offset:5120
    v_mfma_f32_32x32x16_bf16 v[144:159], v[40:43], v[236:239], v[144:159]
    s_add_u32 m0, s43, 2048
    s_cmp_eq_u32 s56, s54
    s_cselect_b32 s56, s57, s56
    buffer_load_dwordx4 v122, s[24:27], s56 offen lds
    v_mfma_f32_32x32x16_bf16 v[160:175], v[44:47], v[232:235], v[160:175]
    buffer_load_dwordx4 v123, s[24:27], s56 offen offset:1024 lds
    s_add_u32 s56, s56, 16384
    v_mfma_f32_32x32x16_bf16 v[176:191], v[44:47], v[236:239], v[176:191]
    buffer_load_dwordx4 v[232:235], v119, s[28:31], s49 offen sc1
    buffer_load_dwordx4 v[236:239], v7, s[28:31], s49 offen sc1
    s_add_u32 s49, s49, 1024
    s_cmp_eq_u32 s49, s51
    s_cselect_b32 s49, s50, s49
    s_call_b64 s[60:61], kf_merge
    s_waitcnt lgkmcnt(0) vmcnt(26)
    v_mfma_f32_32x32x16_bf16 v[128:143], v[16:19], v[240:243], v[128:143]
    ds_read_b64_tr_b16 v[40:41], v124 offset:6144
    ds_read_b64_tr_b16 v[42:43], v124 offset:7168
    ds_read_b64_tr_b16 v[44:45], v125 offset:6144
    ds_read_b64_tr_b16 v[46:47], v125 offset:7168
    v_mfma_f32_32x32x16_bf16 v[144:159], v[16:19], v[244:247], v[144:159]
    s_add_u32 m0, s43, 4096
    s_cmp_eq_u32 s56, s54
    s_cselect_b32 s56, s57, s56
    buffer_load_dwordx4 v122, s[24:27], s56 offen lds
    v_mfma_f32_32x32x16_bf16 v[160:175], v[20:23], v[240:243], v[160:175]
    buffer_load_dwordx4 v123, s[24:27], s56 offen offset:1024 lds
    s_add_u32 s56, s56, 16384
    v_mfma_f32_32x32x16_bf16 v[176:191], v[20:23], v[244:247], v[176:191]
    buffer_load_dwordx4 v[240:243], v119, s[28:31], s49 offen sc1
    buffer_load_dwordx4 v[244:247], v7, s[28:31], s49 offen sc1
    s_add_u32 s49, s49, 1024
    s_cmp_eq_u32 s49, s51
    s_cselect_b32 s49, s50, s49
    s_waitcnt lgkmcnt(0) vmcnt(28)
    v_mfma_f32_32x32x16_bf16 v[128:143], v[40:43], v[248:251], v[128:143]
    ds_read_b64_tr_b16 v[16:17], v124 offset:8192
    ds_read_b64_tr_b16 v[18:19], v124 offset:9216
    ds_read_b64_tr_b16 v[20:21], v125 offset:8192
    ds_read_b64_tr_b16 v[22:23], v125 offset:9216
    v_mfma_f32_32x32x16_bf16 v[144:159], v[40:43], v[252:255], v[144:159]
    s_add_u32 m0, s43, 6144
    s_cmp_eq_u32 s56, s54
    s_cselect_b32 s56, s57, s56
    buffer_load_dwordx4 v122, s[24:27], s56 offen lds
    v_mfma_f32_32x32x16_bf16 v[160:175], v[44:47], v[248:251], v[160:175]
    buffer_load_dwordx4 v123, s[24:27], s56 offen offset:1024 lds
    s_add_u32 s56, s56, 16384
    v_mfma_f32_32x32x16_bf16 v[176:191], v[44:47], v[252:255], v[176:191]
    buffer_load_dwordx4 v[248:251], v119, s[28:31], s49 offen sc1
    buffer_load_dwordx4 v[252:255], v7, s[28:31], s49 offen sc1
    s_add_u32 s49, s49, 1024
    s_cmp_eq_u32 s49, s51
    s_cselect_b32 s49, s50, s49
    s_waitcnt lgkmcnt(0) vmcnt(28)
    v_mfma_f32_32x32x16_bf16 v[128:143], v[16:19], v[192:195], v[128:143]
    ds_read_b64_tr_b16 v[40:41], v124 offset:10240
    ds_read_b64_tr_b16 v[42:43], v124 offset:11264
    ds_read_b64_tr_b16 v[44:45], v125 offset:10240
    ds_read_b64_tr_b16 v[46:47], v125 offset:11264
    v_mfma_f32_32x32x16_bf16 v[144:159], v[16:19], v[196:199], v[144:159]
    s_add_u32 m0, s43, 8192
    s_cmp_eq_u32 s56, s54
    s_cselect_b32 s56, s57, s56
    buffer_load_dwordx4 v122, s[24:27], s56 offen lds
    v_mfma_f32_32x32x16_bf16 v[160:175], v[20:23], v[192:195], v[160:175]
    buffer_load_dwordx4 v123, s[24:27], s56 offen offset:1024 lds
    s_add_u32 s56, s56, 16384
    v_mfma_f32_32x32x16_bf16 v[176:191], v[20:23], v[196:199], v[176:191]
    buffer_load_dwordx4 v[192:195], v119, s[28:31], s49 offen sc1
    buffer_load_dwordx4 v[196:199], v7, s[28:31], s49 offen sc1
    s_add_u32 s49, s49, 1024
    s_cmp_eq_u32 s49, s51
    s_cselect_b32 s49, s50, s49
    s_waitcnt lgkmcnt(0) vmcnt(28)
    v_mfma_f32_32x32x16_bf16 v[128:143], v[40:43], v[200:203], v[128:143]
    ds_read_b64_tr_b16 v[16:17], v124 offset:12288
    ds_read_b64_tr_b16 v[18:19], v124 offset:13312
    ds_read_b64_tr_b16 v[20:21], v125 offset:12288
    ds_read_b64_tr_b16 v[22:23], v125 offset:13312
    v_mfma_f32_32x32x16_bf16 v[144:159], v[40:43], v[204:207], v[144:159]
    s_add_u32 m0, s43, 10240
    s_cmp_eq_u32 s56, s54
    s_cselect_b32 s56, s57, s56
    buffer_load_dwordx4 v122, s[24:27], s56 offen lds
    v_mfma_f32_32x32x16_bf16 v[160:175], v[44:47], v[200:203], v[160:175]
    buffer_load_dwordx4 v123, s[24:27], s56 offen offset:1024 lds
    s_add_u32 s56, s56, 16384
    v_mfma_f32_32x32x16_bf16 v[176:191], v[44:47], v[204:207], v[176:191]
    buffer_load_dwordx4 v[200:203], v119, s[28:31], s49 offen sc1
    buffer_load_dwordx4 v[204:207], v7, s[28:31], s49 offen sc1
    s_add_u32 s49, s49, 1024
    s_cmp_eq_u32 s49, s51
    s_cselect_b32 s49, s50, s49
    s_waitcnt lgkmcnt(0) vmcnt(28)
    v_mfma_f32_32x32x16_bf16 v[128:143], v[16:19], v[208:211], v[128:143]
    ds_read_b64_tr_b16 v[40:41], v124 offset:14336
    ds_read_b64_tr_b16 v[42:43], v124 offset:15360
    ds_read_b64_tr_b16 v[44:45], v125 offset:14336
    ds_read_b64_tr_b16 v[46:47], v125 offset:15360
    v_mfma_f32_32x32x16_bf16 v[144:159], v[16:19], v[212:215], v[144:159]
    s_add_u32 m0, s43, 12288
    s_cmp_eq_u32 s56, s54
    s_cselect_b32 s56, s57, s56
    buffer_load_dwordx4 v122, s[24:27], s56 offen lds
    v_mfma_f32_32x32x16_bf16 v[160:175], v[20:23], v[208:211], v[160:175]
    buffer_load_dwordx4 v123, s[24:27], s56 offen offset:1024 lds
    s_add_u32 s56, s56, 16384
    v_mfma_f32_32x32x16_bf16 v[176:191], v[20:23], v[212:215], v[176:191]
    buffer_load_dwordx4 v[208:211], v119, s[28:31], s49 offen sc1
    buffer_load_dwordx4 v[212:215], v7, s[28:31], s49 offen sc1
    s_add_u32 s49, s49, 1024
    s_cmp_eq_u32 s49, s51
    s_cselect_b32 s49, s50, s49
    s_waitcnt lgkmcnt(0) vmcnt(28)
    v_mfma_f32_32x32x16_bf16 v[128:143], v[40:43], v[216:219], v[128:143]
    ds_read_b64_tr_b16 v[16:17], v4 offset:0
    ds_read_b64_tr_b16 v[18:19], v4 offset:1024
    ds_read_b64_tr_b16 v[20:21], v5 offset:0
    ds_read_b64_tr_b16 v[22:23], v5 offset:1024
    v_mfma_f32_32x32x16_bf16 v[144:159], v[40:43], v[220:223], v[144:159]
    s_add_u32 m0, s43, 14336
    s_cmp_eq_u32 s56, s54
    s_cselect_b32 s56, s57, s56
    buffer_load_dwordx4 v122, s[24:27], s56 offen lds
    v_mfma_f32_32x32x16_bf16 v[160:175], v[44:47], v[216:219], v[160:175]
    buffer_load_dwordx4 v123, s[24:27], s56 offen offset:1024 lds
    s_add_u32 s56, s56, 16384
    v_mfma_f32_32x32x16_bf16 v[176:191], v[44:47], v[220:223], v[176:191]
    buffer_load_dwordx4 v[216:219], v119, s[28:31], s49 offen sc1
    buffer_load_dwordx4 v[220:223], v7, s[28:31], s49 offen sc1
    s_add_u32 s49, s49, 1024
    s_cmp_eq_u32 s49, s51
    s_cselect_b32 s49, s50, s49
    s_call_b64 s[60:61], kf_merge
    s_waitcnt lgkmcnt(0) vmcnt(28)
    v_mfma_f32_32x32x16_bf16 v[128:143], v[16:19], v[224:227], v[128:143]
    ds_read_b64_tr_b16 v[40:41], v4 offset:2048
    ds_read_b64_tr_b16 v[42:43], v4 offset:3072
    ds_read_b64_tr_b16 v[44:45], v5 offset:2048
    ds_read_b64_tr_b16 v[46:47], v5 offset:3072
    v_mfma_f32_32x32x16_bf16 v[144:159], v[16:19], v[228:231], v[144:159]
    s_add_u32 m0, s47, 0
    s_cmp_eq_u32 s56, s54
    s_cselect_b32 s56, s57, s56
    buffer_load_dwordx4 v122, s[24:27], s56 offen lds
    v_mfma_f32_32x32x16_bf16 v[160:175], v[20:23], v[224:227], v[160:175]
    buffer_load_dwordx4 v123, s[24:27], s56 offen offset:1024 lds
    s_add_u32 s56, s56, 16384
    v_mfma_f32_32x32x16_bf16 v[176:191], v[20:23], v[228:231], v[176:191]
    buffer_load_dwordx4 v[224:227], v119, s[28:31], s49 offen sc1
    buffer_load_dwordx4 v[228:231], v7, s[28:31], s49 offen sc1
    s_add_u32 s49, s49, 1024
    s_cmp_eq_u32 s49, s51
    s_cselect_b32 s49, s50, s49
    s_waitcnt lgkmcnt(0) vmcnt(28)
    v_mfma_f32_32x32x16_bf16 v[128:143], v[40:43], v[232:235], v[128:143]
    ds_read_b64_tr_b16 v[16:17], v4 offset:4096
    ds_read_b64_tr_b16 v[18:19], v4 offset:5120
    ds_read_b64_tr_b16 v[20:21], v5 offset:4096
    ds_read_b64_tr_b16 v[22:23], v5 offset:5120
    v_mfma_f32_32x32x16_bf16 v[144:159], v[40:43], v[236:239], v[144:159]
    s_add_u32 m0, s47, 2048
    s_cmp_eq_u32 s56, s54
    s_cselect_b32 s56, s57, s56
    buffer_load_dwordx4 v122, s[24:27], s56 offen lds
    v_mfma_f32_32x32x16_bf16 v[160:175], v[44:47], v[232:235], v[160:175]
    buffer_load_dwordx4 v123, s[24:27], s56 offen offset:1024 lds
    s_add_u32 s56, s56, 16384
    v_mfma_f32_32x32x16_bf16 v[176:191], v[44:47], v[236:239], v[176:191]
    buffer_load_dwordx4 v[232:235], v119, s[28:31], s49 offen sc1
    buffer_load_dwordx4 v[236:239], v7, s[28:31], s49 offen sc1
    s_add_u32 s49, s49, 1024
    s_cmp_eq_u32 s49, s51
    s_cselect_b32 s49, s50, s49
    s_waitcnt lgkmcnt(0) vmcnt(28)
    v_mfma_f32_32x32x16_bf16 v[128:143], v[16:19], v[240:243], v[128:143]
    ds_read_b64_tr_b16 v[40:41], v4 offset:6144
    ds_read_b64_tr_b16 v[42:43], v4 offset:7168
    ds_read_b64_tr_b16 v[44:45], v5 offset:6144
    ds_read_b64_tr_b16 v[46:47], v5 offset:7168
    v_mfma_f32_32x32x16_bf16 v[144:159], v[16:19], v[244:247], v[144:159]
    s_add_u32 m0, s47, 4096
    s_cmp_eq_u32 s56, s54
    s_cselect_b32 s56, s57, s56
    buffer_load_dwordx4 v122, s[24:27], s56 offen lds
    v_mfma_f32_32x32x16_bf16 v[160:175], v[20:23], v[240:243], v[160:175]
    buffer_load_dwordx4 v123, s[24:27], s56 offen offset:1024 lds
    s_add_u32 s56, s56, 16384
    v_mfma_f32_32x32x16_bf16 v[176:191], v[20:23], v[244:247], v[176:191]
    buffer_load_dwordx4 v[240:243], v119, s[28:31], s49 offen sc1
    buffer_load_dwordx4 v[244:247], v7, s[28:31], s49 offen sc1
    s_add_u32 s49, s49, 1024
    s_cmp_eq_u32 s49, s51
    s_cselect_b32 s49, s50, s49
    s_waitcnt lgkmcnt(0) vmcnt(28)
    v_mfma_f32_32x32x16_bf16 v[128:143], v[40:43], v[248:251], v[128:143]
    ds_read_b64_tr_b16 v[16:17], v124 offset:0
    ds_read_b64_tr_b16 v[18:19], v124 offset:1024
    ds_read_b64_tr_b16 v[20:21], v125 offset:0
    ds_read_b64_tr_b16 v[22:23], v125 offset:1024
    v_mfma_f32_32x32x16_bf16 v[144:159], v[40:43], v[252:255], v[144:159]
    s_add_u32 m0, s47, 6144
    s_cmp_eq_u32 s56, s54
    s_cselect_b32 s56, s57, s56
    buffer_load_dwordx4 v122, s[24:27], s56 offen lds
    v_mfma_f32_32x32x16_bf16 v[160:175], v[44:47], v[248:251], v[160:175]
    buffer_load_dwordx4 v123, s[24:27], s56 offen offset:1024 lds
    s_add_u32 s56, s56, 16384
    v_mfma_f32_32x32x16_bf16 v[176:191], v[44:47], v[252:255], v[176:191]
    buffer_load_dwordx4 v[248:251], v119, s[28:31], s49 offen sc1
    buffer_load_dwordx4 v[252:255], v7, s[28:31], s49 offen sc1
    s_add_u32 s49, s49, 1024
    s_cmp_eq_u32 s49, s51
    s_cselect_b32 s49, s50, s49
    s_waitcnt lgkmcnt(0) vmcnt(28)
    v_mfma_f32_32x32x16_bf16 v[128:143], v[16:19], v[192:195], v[128:143]
    ds_read_b64_tr_b16 v[40:41], v124 offset:2048
    ds_read_b64_tr_b16 v[42:43], v124 offset:3072
    ds_read_b64_tr_b16 v[44:45], v125 offset:2048
    ds_read_b64_tr_b16 v[46:47], v125 offset:3072
    v_mfma_f32_32x32x16_bf16 v[144:159], v[16:19], v[196:199], v[144:159]
    s_add_u32 m0, s43, 0
    s_add_u32 s48, s46, 0
    buffer_load_dwordx4 v122, s[20:23], s48 offen lds
    v_mfma_f32_32x32x16_bf16 v[160:175], v[20:23], v[192:195], v[160:175]
    buffer_load_dwordx4 v123, s[20:23], s48 offen offset:1024 lds
    v_mfma_f32_32x32x16_bf16 v[176:191], v[20:23], v[196:199], v[176:191]
    buffer_load_dwordx4 v[192:195], v119, s[28:31], s49 offen sc1
    buffer_load_dwordx4 v[196:199], v7, s[28:31], s49 offen sc1
    s_add_u32 s49, s49, 1024
    s_cmp_eq_u32 s49, s51
    s_cselect_b32 s49, s50, s49
    s_waitcnt lgkmcnt(0) vmcnt(28)
    v_mfma_f32_32x32x16_bf16 v[128:143], v[40:43], v[200:203], v[128:143]
    ds_read_b64_tr_b16 v[16:17], v124 offset:4096
    ds_read_b64_tr_b16 v[18:19], v124 offset:5120
    ds_read_b64_tr_b16 v[20:21], v125 offset:4096
    ds_read_b64_tr_b16 v[22:23], v125 offset:5120
    v_mfma_f32_32x32x16_bf16 v[144:159], v[40:43], v[204:207], v[144:159]
    s_add_u32 m0, s43, 2048
    s_add_u32 s48, s46, 16384
    buffer_load_dwordx4 v122, s[20:23], s48 offen lds
    v_mfma_f32_32x32x16_bf16 v[160:175], v[44:47], v[200:203], v[160:175]
    buffer_load_dwordx4 v123, s[20:23], s48 offen offset:1024 lds
    v_mfma_f32_32x32x16_bf16 v[176:191], v[44:47], v[204:207], v[176:191]
    buffer_load_dwordx4 v[200:203], v119, s[28:31], s49 offen sc1
    buffer_load_dwordx4 v[204:207], v7, s[28:31], s49 offen sc1
    s_add_u32 s49, s49, 1024
    s_cmp_eq_u32 s49, s51
    s_cselect_b32 s49, s50, s49
    s_call_b64 s[60:61], kf_merge
    s_waitcnt lgkmcnt(0) vmcnt(28)
    v_mfma_f32_32x32x16_bf16 v[128:143], v[16:19], v[208:211], v[128:143]
    ds_read_b64_tr_b16 v[40:41], v124 offset:6144
    ds_read_b64_tr_b16 v[42:43], v124 offset:7168
    ds_read_b64_tr_b16 v[44:45], v125 offset:6144
    ds_read_b64_tr_b16 v[46:47], v125 offset:7168
    v_mfma_f32_32x32x16_bf16 v[144:159], v[16:19], v[212:215], v[144:159]
    s_add_u32 m0, s43, 4096
    s_add_u32 s48, s46, 32768
    buffer_load_dwordx4 v122, s[20:23], s48 offen lds
    v_mfma_f32_32x32x16_bf16 v[160:175], v[20:23], v[208:211], v[160:175]
    buffer_load_dwordx4 v123, s[20:23], s48 offen offset:1024 lds
    v_mfma_f32_32x32x16_bf16 v[176:191], v[20:23], v[212:215], v[176:191]
    buffer_load_dwordx4 v[208:211], v119, s[28:31], s49 offen sc1
    buffer_load_dwordx4 v[212:215], v7, s[28:31], s49 offen sc1
    s_add_u32 s49, s49, 1024
    s_cmp_eq_u32 s49, s51
    s_cselect_b32 s49, s50, s49
    s_waitcnt lgkmcnt(0) vmcnt(28)
    v_mfma_f32_32x32x16_bf16 v[128:143], v[40:43], v[216:219], v[128:143]
    ds_read_b64_tr_b16 v[16:17], v124 offset:8192
    ds_read_b64_tr_b16 v[18:19], v124 offset:9216
    ds_read_b64_tr_b16 v[20:21], v125 offset:8192
    ds_read_b64_tr_b16 v[22:23], v125 offset:9216
    v_mfma_f32_32x32x16_bf16 v[144:159], v[40:43], v[220:223], v[144:159]
    s_add_u32 m0, s43, 6144
    s_add_u32 s48, s46, 49152
    buffer_load_dwordx4 v122, s[20:23], s48 offen lds
    v_mfma_f32_32x32x16_bf16 v[160:175], v[44:47], v[216:219], v[160:175]
    buffer_load_dwordx4 v123, s[20:23], s48 offen offset:1024 lds
    v_mfma_f32_32x32x16_bf16 v[176:191], v[44:47], v[220:223], v[176:191]
    buffer_load_dwordx4 v[216:219], v119, s[28:31], s49 offen sc1
    buffer_load_dwordx4 v[220:223], v7, s[28:31], s49 offen sc1
    s_add_u32 s49, s49, 1024
    s_cmp_eq_u32 s49, s51
    s_cselect_b32 s49, s50, s49
    s_waitcnt lgkmcnt(0) vmcnt(28)
    v_mfma_f32_32x32x16_bf16 v[128:143], v[16:19], v[224:227], v[128:143]
    ds_read_b64_tr_b16 v[40:41], v124 offset:10240
    ds_read_b64_tr_b16 v[42:43], v124 offset:11264
    ds_read_b64_tr_b16 v[44:45], v125 offset:10240
    ds_read_b64_tr_b16 v[46:47], v125 offset:11264
    v_mfma_f32_32x32x16_bf16 v[144:159], v[16:19], v[228:231], v[144:159]
    s_add_u32 m0, s43, 8192
    s_add_u32 s48, s46, 65536
    buffer_load_dwordx4 v122, s[20:23], s48 offen lds
    v_mfma_f32_32x32x16_bf16 v[160:175], v[20:23], v[224:227], v[160:175]
    buffer_load_dwordx4 v123, s[20:23], s48 offen offset:1024 lds
    v_mfma_f32_32x32x16_bf16 v[176:191], v[20:23], v[228:231], v[176:191]
    s_add_u32 s48, s45, 0
    buffer_load_dwordx4 v[224:227], v1, s[28:31], s48 offen offset:0 sc1
    buffer_load_dwordx4 v[228:231], v1, s[28:31], s48 offen offset:1024 sc1
    s_waitcnt lgkmcnt(0) vmcnt(28)
    v_mfma_f32_32x32x16_bf16 v[128:143], v[40:43], v[232:235], v[128:143]
    ds_read_b64_tr_b16 v[16:17], v124 offset:12288
    ds_read_b64_tr_b16 v[18:19], v124 offset:13312
    ds_read_b64_tr_b16 v[20:21], v125 offset:12288
    ds_read_b64_tr_b16 v[22:23], v125 offset:13312
    v_mfma_f32_32x32x16_bf16 v[144:159], v[40:43], v[236:239], v[144:159]
    s_add_u32 m0, s43, 10240
    s_add_u32 s48, s46, 81920
    buffer_load_dwordx4 v122, s[20:23], s48 offen lds
    v_mfma_f32_32x32x16_bf16 v[160:175], v[44:47], v[232:235], v[160:175]
    buffer_load_dwordx4 v123, s[20:23], s48 offen offset:1024 lds
    v_mfma_f32_32x32x16_bf16 v[176:191], v[44:47], v[236:239], v[176:191]
    s_add_u32 s48, s45, 4096
    buffer_load_dwordx4 v[232:235], v1, s[28:31], s48 offen offset:0 sc1
    buffer_load_dwordx4 v[236:239], v1, s[28:31], s48 offen offset:1024 sc1
    s_waitcnt lgkmcnt(0) vmcnt(28)
    v_mfma_f32_32x32x16_bf16 v[128:143], v[16:19], v[240:243], v[128:143]
    ds_read_b64_tr_b16 v[40:41], v124 offset:14336
    ds_read_b64_tr_b16 v[42:43], v124 offset:15360
    ds_read_b64_tr_b16 v[44:45], v125 offset:14336
    ds_read_b64_tr_b16 v[46:47], v125 offset:15360
    v_mfma_f32_32x32x16_bf16 v[144:159], v[16:19], v[244:247], v[144:159]
    s_add_u32 m0, s43, 12288
    s_add_u32 s48, s46, 98304
    buffer_load_dwordx4 v122, s[20:23], s48 offen lds
    v_mfma_f32_32x32x16_bf16 v[160:175], v[20:23], v[240:243], v[160:175]
    buffer_load_dwordx4 v123, s[20:23], s48 offen offset:1024 lds
    v_mfma_f32_32x32x16_bf16 v[176:191], v[20:23], v[244:247], v[176:191]
    s_add_u32 s48, s45, 8192
    buffer_load_dwordx4 v[240:243], v1, s[28:31], s48 offen offset:0 sc1
    buffer_load_dwordx4 v[244:247], v1, s[28:31], s48 offen offset:1024 sc1
    s_waitcnt lgkmcnt(0) vmcnt(28)
    v_mfma_f32_32x32x16_bf16 v[128:143], v[40:43], v[248:251], v[128:143]
    ds_read_b64_tr_b16 v[16:17], v4 offset:0
    ds_read_b64_tr_b16 v[18:19], v4 offset:1024
    ds_read_b64_tr_b16 v[20:21], v5 offset:0
    ds_read_b64_tr_b16 v[22:23], v5 offset:1024
    v_mfma_f32_32x32x16_bf16 v[144:159], v[40:43], v[252:255], v[144:159]
    s_add_u32 m0, s43, 14336
    s_add_u32 s48, s46, 114688
    buffer_load_dwordx4 v122, s[20:23], s48 offen lds
    v_mfma_f32_32x32x16_bf16 v[160:175], v[44:47], v[248:251], v[160:175]
    buffer_load_dwordx4 v123, s[20:23], s48 offen offset:1024 lds
    v_mfma_f32_32x32x16_bf16 v[176:191], v[44:47], v[252:255], v[176:191]
    s_add_u32 s48, s45, 12288
    buffer_load_dwordx4 v[248:251], v1, s[28:31], s48 offen offset:0 sc1
    buffer_load_dwordx4 v[252:255], v1, s[28:31], s48 offen offset:1024 sc1
    s_call_b64 s[60:61], kf_merge
    s_waitcnt lgkmcnt(0) vmcnt(28)
    v_mfma_f32_32x32x16_bf16 v[128:143], v[16:19], v[192:195], v[128:143]
    ds_read_b64_tr_b16 v[40:41], v4 offset:2048
    ds_read_b64_tr_b16 v[42:43], v4 offset:3072
    ds_read_b64_tr_b16 v[44:45], v5 offset:2048
    ds_read_b64_tr_b16 v[46:47], v5 offset:3072
    v_mfma_f32_32x32x16_bf16 v[144:159], v[16:19], v[196:199], v[144:159]
    v_mfma_f32_32x32x16_bf16 v[160:175], v[20:23], v[192:195], v[160:175]
    v_mfma_f32_32x32x16_bf16 v[176:191], v[20:23], v[196:199], v[176:191]
    s_add_u32 s48, s45, 16384
    buffer_load_dwordx4 v[192:195], v1, s[28:31], s48 offen offset:0 sc1
    buffer_load_dwordx4 v[196:199], v1, s[28:31], s48 offen offset:1024 sc1
    s_waitcnt lgkmcnt(0) vmcnt(26)
    v_mfma_f32_32x32x16_bf16 v[128:143], v[40:43], v[200:203], v[128:143]
    ds_read_b64_tr_b16 v[16:17], v4 offset:4096
    ds_read_b64_tr_b16 v[18:19], v4 offset:5120
    ds_read_b64_tr_b16 v[20:21], v5 offset:4096
    ds_read_b64_tr_b16 v[22:23], v5 offset:5120
    v_mfma_f32_32x32x16_bf16 v[144:159], v[40:43], v[204:207], v[144:159]
    v_mfma_f32_32x32x16_bf16 v[160:175], v[44:47], v[200:203], v[160:175]
    v_mfma_f32_32x32x16_bf16 v[176:191], v[44:47], v[204:207], v[176:191]
    s_add_u32 s48, s45, 20480
    buffer_load_dwordx4 v[200:203], v1, s[28:31], s48 offen offset:0 sc1
    buffer_load_dwordx4 v[204:207], v1, s[28:31], s48 offen offset:1024 sc1
    s_waitcnt lgkmcnt(0) vmcnt(24)
    v_mfma_f32_32x32x16_bf16 v[128:143], v[16:19], v[208:211], v[128:143]
    ds_read_b64_tr_b16 v[40:41], v4 offset:6144
    ds_read_b64_tr_b16 v[42:43], v4 offset:7168
    ds_read_b64_tr_b16 v[44:45], v5 offset:6144
    ds_read_b64_tr_b16 v[46:47], v5 offset:7168
    v_mfma_f32_32x32x16_bf16 v[144:159], v[16:19], v[212:215], v[144:159]
    v_mfma_f32_32x32x16_bf16 v[160:175], v[20:23], v[208:211], v[160:175]
    v_mfma_f32_32x32x16_bf16 v[176:191], v[20:23], v[212:215], v[176:191]
    s_add_u32 s48, s45, 24576
    buffer_load_dwordx4 v[208:211], v1, s[28:31], s48 offen offset:0 sc1
    buffer_load_dwordx4 v[212:215], v1, s[28:31], s48 offen offset:1024 sc1
    s_waitcnt lgkmcnt(0) vmcnt(22)
    v_mfma_f32_32x32x16_bf16 v[128:143], v[40:43], v[216:219], v[128:143]
    v_mfma_f32_32x32x16_bf16 v[144:159], v[40:43], v[220:223], v[144:159]
    v_mfma_f32_32x32x16_bf16 v[160:175], v[44:47], v[216:219], v[160:175]
    v_mfma_f32_32x32x16_bf16 v[176:191], v[44:47], v[220:223], v[176:191]
    s_add_u32 s48, s45, 28672
    buffer_load_dwordx4 v[216:219], v1, s[28:31], s48 offen offset:0 sc1
    buffer_load_dwordx4 v[220:223], v1, s[28:31], s48 offen offset:1024 sc1
    s_mov_b32 s16, s4
    s_and_b32 s17, s5, 0xffff
    s_mov_b32 s18, 2097152
    s_mov_b32 s19, 0x20000
    s_mov_b32 s20, s70
    s_and_b32 s21, s71, 0xffff
    s_mov_b32 s22, 2097152
    s_mov_b32 s23, 0x20000
    s_setprio 3
    s_lshr_b32 s41, s42, 1
    s_lshl_b32 s41, s41, 6
    s_add_u32 s46, s44, s41
    s_add_u32 s46, s46, s57
    v_and_b32 v7, 31, v2
    v_lshlrev_b32 v7, 10, v7
    v_lshrrev_b32 v10, 5, v2
    v_lshl_add_u32 v7, v10, 4, v7
    v_subrev_u32 v124, s43, v124
kf_e0:
    s_cmp_ge_u32 s62, 2
    s_cbranch_scc1 kf_e1
    s_call_b64 s[60:61], kf_merge
    s_branch kf_e0
kf_e1:
    s_setprio 3
    v_add_u32 v10, s47, v1
    s_add_u32 s40, s47, 8192
    s_cmp_eq_u32 s35, 3
    s_cselect_b32 s40, 81920, s40
    v_add_u32 v11, s40, v1
    ds_write_b128 v10, v[144:147] offset:0
    ds_write_b128 v10, v[148:151] offset:1024
    ds_write_b128 v10, v[152:155] offset:2048
    ds_write_b128 v10, v[156:159] offset:3072
    ds_write_b128 v10, v[160:163] offset:4096
    ds_write_b128 v10, v[164:167] offset:5120
    ds_write_b128 v10, v[168:171] offset:6144
    ds_write_b128 v10, v[172:175] offset:7168
    ds_write_b128 v11, v[176:179] offset:0
    ds_write_b128 v11, v[180:183] offset:1024
    ds_write_b128 v11, v[184:187] offset:2048
    ds_write_b128 v11, v[188:191] offset:3072
    s_xor_b32 s40, s35, 1
    s_mul_i32 s40, s40, 12288
    s_add_u32 s40, s40, 118784
    v_add_u32 v12, s40, v1
    s_xor_b32 s40, s35, 2
    s_mul_i32 s40, s40, 12288
    s_add_u32 s40, s40, 122880
    v_add_u32 v13, s40, v1
    s_xor_b32 s40, s35, 3
    s_mul_i32 s40, s40, 12288
    s_add_u32 s40, s40, 126976
    s_cmp_eq_u32 s35, 0
    s_cselect_b32 s40, 81920, s40
    v_add_u32 v14, s40, v1
    s_waitcnt lgkmcnt(0) vmcnt(10)
    v_mov_b32 v8, 100388
    v_mov_b32 v9, 1
    s_mov_b64 exec, 1
    ds_add_u32 v8, v9
    s_mov_b64 exec, -1
    s_call_b64 s[60:61], kf_merge
    buffer_load_dwordx4 v[112:115], v7, s[16:19], s46 offen
    buffer_load_dwordx4 v[116:119], v7, s[16:19], s46 offen offset:32
    s_add_u32 s48, s45, 0
    buffer_load_dwordx4 v[16:19], v1, s[28:31], s48 offen offset:2048 sc1
    s_add_u32 s48, s45, 4096
    buffer_load_dwordx4 v[20:23], v1, s[28:31], s48 offen offset:2048 sc1
    s_add_u32 s48, s45, 8192
    buffer_load_dwordx4 v[24:27], v1, s[28:31], s48 offen offset:2048 sc1
    s_add_u32 s48, s45, 12288
    buffer_load_dwordx4 v[28:31], v1, s[28:31], s48 offen offset:2048 sc1
    s_add_u32 s48, s45, 16384
    buffer_load_dwordx4 v[32:35], v1, s[28:31], s48 offen offset:2048 sc1
    s_add_u32 s48, s45, 20480
    buffer_load_dwordx4 v[36:39], v1, s[28:31], s48 offen offset:2048 sc1
    s_add_u32 s48, s45, 24576
    buffer_load_dwordx4 v[40:43], v1, s[28:31], s48 offen offset:2048 sc1
    s_add_u32 s48, s45, 28672
    buffer_load_dwordx4 v[44:47], v1, s[28:31], s48 offen offset:2048 sc1
2:
    ds_read_b32 v9, v8
    s_waitcnt lgkmcnt(0)
    s_setprio 3
    v_readfirstlane_b32 s40, v9
    s_nop 0
    s_cmp_ge_u32 s40, 4
    s_cbranch_scc1 3f
    s_call_b64 s[60:61], kf_merge
    s_sleep 1
    s_branch 2b
3:
    ds_read_b128 v[144:147], v12 offset:0
    ds_read_b128 v[148:151], v12 offset:1024
    ds_read_b128 v[152:155], v12 offset:2048
    ds_read_b128 v[156:159], v12 offset:3072
    ds_read_b128 v[160:163], v13 offset:0
    ds_read_b128 v[164:167], v13 offset:1024
    ds_read_b128 v[168:171], v13 offset:2048
    ds_read_b128 v[172:175], v13 offset:3072
    ds_read_b128 v[176:179], v14 offset:0
    ds_read_b128 v[180:183], v14 offset:1024
    ds_read_b128 v[184:187], v14 offset:2048
    ds_read_b128 v[188:191], v14 offset:3072
    s_mov_b32 s40, 0xbfb8aa3b
    s_waitcnt lgkmcnt(8)
    v_pk_add_f32 v[128:129], v[128:129], v[144:145]
    v_pk_add_f32 v[130:131], v[130:131], v[146:147]
    v_pk_add_f32 v[132:133], v[132:133], v[148:149]
    v_pk_add_f32 v[134:135], v[134:135], v[150:151]
    v_pk_add_f32 v[136:137], v[136:137], v[152:153]
    v_pk_add_f32 v[138:139], v[138:139], v[154:155]
    v_pk_add_f32 v[140:141], v[140:141], v[156:157]
    v_pk_add_f32 v[142:143], v[142:143], v[158:159]
    s_waitcnt lgkmcnt(0)
    v_pk_add_f32 v[160:161], v[160:161], v[176:177]
    v_pk_add_f32 v[162:163], v[162:163], v[178:179]
    v_pk_add_f32 v[164:165], v[164:165], v[180:181]
    v_pk_add_f32 v[166:167], v[166:167], v[182:183]
    v_pk_add_f32 v[168:169], v[168:169], v[184:185]
    v_pk_add_f32 v[170:171], v[170:171], v[186:187]
    v_pk_add_f32 v[172:173], v[172:173], v[188:189]
    v_pk_add_f32 v[174:175], v[174:175], v[190:191]
    v_pk_add_f32 v[128:129], v[128:129], v[160:161]
    v_pk_add_f32 v[130:131], v[130:131], v[162:163]
    v_pk_add_f32 v[132:133], v[132:133], v[164:165]
    v_pk_add_f32 v[134:135], v[134:135], v[166:167]
    v_pk_add_f32 v[136:137], v[136:137], v[168:169]
    v_pk_add_f32 v[138:139], v[138:139], v[170:171]
    v_pk_add_f32 v[140:141], v[140:141], v[172:173]
    v_pk_add_f32 v[142:143], v[142:143], v[174:175]
    ds_read_b64_tr_b16 v[160:161], v124 offset:0
    ds_read_b64_tr_b16 v[162:163], v124 offset:1024
    ds_read_b64_tr_b16 v[164:165], v124 offset:8192
    ds_read_b64_tr_b16 v[166:167], v124 offset:9216
    ds_read_b64_tr_b16 v[168:169], v124 offset:16384
    ds_read_b64_tr_b16 v[170:171], v124 offset:17408
    ds_read_b64_tr_b16 v[172:173], v124 offset:24576
    ds_read_b64_tr_b16 v[174:175], v124 offset:25600
    ds_read_b64_tr_b16 v[176:177], v124 offset:32768
    ds_read_b64_tr_b16 v[178:179], v124 offset:33792
    ds_read_b64_tr_b16 v[180:181], v124 offset:40960
    ds_read_b64_tr_b16 v[182:183], v124 offset:41984
    ds_read_b64_tr_b16 v[184:185], v124 offset:49152
    ds_read_b64_tr_b16 v[186:187], v124 offset:50176
    ds_read_b64_tr_b16 v[188:189], v124 offset:57344
    ds_read_b64_tr_b16 v[190:191], v124 offset:58368
    s_call_b64 s[60:61], kf_merge
    s_waitcnt vmcnt(10)
kf_b0:
    s_setprio 3
    v_max3_u32 v15, v224, v232, v240
    v_max3_u32 v15, v248, v192, v15
    v_max3_u32 v15, v200, v208, v15
    v_max_u32 v15, v216, v15
    v_cmp_eq_u32 vcc, -1, v15
    s_nop 0
    s_cbranch_vccz kf_b0x
    s_setprio 0
    s_cmp_lt_u32 s62, 7
    s_cbranch_scc1 1f
    s_sleep 16
1:
    s_add_u32 s48, s45, 0
    buffer_load_dwordx4 v[224:227], v1, s[28:31], s48 offen offset:0 sc1
    s_add_u32 s48, s45, 4096
    buffer_load_dwordx4 v[232:235], v1, s[28:31], s48 offen offset:0 sc1
    s_add_u32 s48, s45, 8192
    buffer_load_dwordx4 v[240:243], v1, s[28:31], s48 offen offset:0 sc1
    s_add_u32 s48, s45, 12288
    buffer_load_dwordx4 v[248:251], v1, s[28:31], s48 offen offset:0 sc1
    s_add_u32 s48, s45, 16384
    buffer_load_dwordx4 v[192:195], v1, s[28:31], s48 offen offset:0 sc1
    s_add_u32 s48, s45, 20480
    buffer_load_dwordx4 v[200:203], v1, s[28:31], s48 offen offset:0 sc1
    s_add_u32 s48, s45, 24576
    buffer_load_dwordx4 v[208:211], v1, s[28:31], s48 offen offset:0 sc1
    s_add_u32 s48, s45, 28672
    buffer_load_dwordx4 v[216:219], v1, s[28:31], s48 offen offset:0 sc1
    s_mov_b32 s41, 5
1:
    s_cmp_ge_u32 s62, 7
    s_cbranch_scc1 2f
    s_call_b64 s[60:61], kf_merge
    s_sleep 1
    s_sub_u32 s41, s41, 1
    s_cbranch_scc0 1b
2:
    s_waitcnt vmcnt(0)
    s_branch kf_b0
kf_b0x:
    s_waitcnt lgkmcnt(14)
    v_mfma_f32_32x32x16_bf16 v[144:159], v[160:163], v[224:227], 0
    ds_read_b64_tr_b16 v[160:161], v124 offset:2048
    ds_read_b64_tr_b16 v[162:163], v124 offset:3072
    v_mul_f32 v48, s40, v128
    v_mul_f32 v49, s40, v129
    v_mul_f32 v50, s40, v130
    v_mul_f32 v51, s40, v131
    s_waitcnt lgkmcnt(14)
    v_mfma_f32_32x32x16_bf16 v[144:159], v[164:167], v[232:235], v[144:159]
    ds_read_b64_tr_b16 v[164:165], v124 offset:10240
    ds_read_b64_tr_b16 v[166:167], v124 offset:11264
    v_mul_f32 v52, s40, v132
    v_mul_f32 v53, s40, v133
    v_mul_f32 v54, s40, v134
    v_mul_f32 v55, s40, v135
    s_waitcnt lgkmcnt(14)
    v_mfma_f32_32x32x16_bf16 v[144:159], v[168:171], v[240:243], v[144:159]
    ds_read_b64_tr_b16 v[168:169], v124 offset:18432
    ds_read_b64_tr_b16 v[170:171], v124 offset:19456
    v_mul_f32 v56, s40, v136
    v_mul_f32 v57, s40, v137
    v_mul_f32 v58, s40, v138
    v_mul_f32 v59, s40, v139
    s_waitcnt lgkmcnt(14)
    v_mfma_f32_32x32x16_bf16 v[144:159], v[172:175], v[248:251], v[144:159]
    ds_read_b64_tr_b16 v[172:173], v124 offset:26624
    ds_read_b64_tr_b16 v[174:175], v124 offset:27648
    v_mul_f32 v60, s40, v140
    v_mul_f32 v61, s40, v141
    v_mul_f32 v62, s40, v142
    v_mul_f32 v63, s40, v143
    s_waitcnt lgkmcnt(14)
    v_mfma_f32_32x32x16_bf16 v[144:159], v[176:179], v[192:195], v[144:159]
    ds_read_b64_tr_b16 v[176:177], v124 offset:34816
    ds_read_b64_tr_b16 v[178:179], v124 offset:35840
    v_exp_f32 v48, v48
    v_exp_f32 v49, v49
    v_exp_f32 v50, v50
    v_exp_f32 v51, v51
    s_waitcnt lgkmcnt(14)
    v_mfma_f32_32x32x16_bf16 v[144:159], v[180:183], v[200:203], v[144:159]
    ds_read_b64_tr_b16 v[180:181], v124 offset:43008
    ds_read_b64_tr_b16 v[182:183], v124 offset:44032
    v_exp_f32 v52, v52
    v_exp_f32 v53, v53
    v_exp_f32 v54, v54
    v_exp_f32 v55, v55
    s_waitcnt lgkmcnt(14)
    v_mfma_f32_32x32x16_bf16 v[144:159], v[184:187], v[208:211], v[144:159]
    ds_read_b64_tr_b16 v[184:185], v124 offset:51200
    ds_read_b64_tr_b16 v[186:187], v124 offset:52224
    v_exp_f32 v56, v56
    v_exp_f32 v57, v57
    v_exp_f32 v58, v58
    v_exp_f32 v59, v59
    s_waitcnt lgkmcnt(14)
    v_mfma_f32_32x32x16_bf16 v[144:159], v[188:191], v[216:219], v[144:159]
    ds_read_b64_tr_b16 v[188:189], v124 offset:59392
    ds_read_b64_tr_b16 v[190:191], v124 offset:60416
    v_exp_f32 v60, v60
    v_exp_f32 v61, v61
    v_exp_f32 v62, v62
    v_exp_f32 v63, v63
    s_call_b64 s[60:61], kf_merge
    s_waitcnt vmcnt(10)
kf_b1:
    s_setprio 3
    v_max3_u32 v15, v228, v236, v244
    v_max3_u32 v15, v252, v196, v15
    v_max3_u32 v15, v204, v212, v15
    v_max_u32 v15, v220, v15
    v_cmp_eq_u32 vcc, -1, v15
    s_nop 0
    s_cbranch_vccz kf_b1x
    s_setprio 0
    s_cmp_lt_u32 s62, 7
    s_cbranch_scc1 1f
    s_sleep 16
1:
    s_add_u32 s48, s45, 0
    buffer_load_dwordx4 v[228:231], v1, s[28:31], s48 offen offset:1024 sc1
    s_add_u32 s48, s45, 4096
    buffer_load_dwordx4 v[236:239], v1, s[28:31], s48 offen offset:1024 sc1
    s_add_u32 s48, s45, 8192
    buffer_load_dwordx4 v[244:247], v1, s[28:31], s48 offen offset:1024 sc1
    s_add_u32 s48, s45, 12288
    buffer_load_dwordx4 v[252:255], v1, s[28:31], s48 offen offset:1024 sc1
    s_add_u32 s48, s45, 16384
    buffer_load_dwordx4 v[196:199], v1, s[28:31], s48 offen offset:1024 sc1
    s_add_u32 s48, s45, 20480
    buffer_load_dwordx4 v[204:207], v1, s[28:31], s48 offen offset:1024 sc1
    s_add_u32 s48, s45, 24576
    buffer_load_dwordx4 v[212:215], v1, s[28:31], s48 offen offset:1024 sc1
    s_add_u32 s48, s45, 28672
    buffer_load_dwordx4 v[220:223], v1, s[28:31], s48 offen offset:1024 sc1
    s_mov_b32 s41, 5
1:
    s_cmp_ge_u32 s62, 7
    s_cbranch_scc1 2f
    s_call_b64 s[60:61], kf_merge
    s_sleep 1
    s_sub_u32 s41, s41, 1
    s_cbranch_scc0 1b
2:
    s_waitcnt vmcnt(0)
    s_branch kf_b1
kf_b1x:
    s_waitcnt lgkmcnt(14)
    v_mfma_f32_32x32x16_bf16 v[144:159], v[160:163], v[228:231], v[144:159]
    ds_read_b64_tr_b16 v[160:161], v124 offset:4096
    ds_read_b64_tr_b16 v[162:163], v124 offset:5120
    v_add_f32 v48, 1.0, v48
    v_add_f32 v49, 1.0, v49
    v_add_f32 v50, 1.0, v50
    v_add_f32 v51, 1.0, v51
    s_add_u32 s48, s45, 0
    buffer_load_dwordx4 v[224:227], v1, s[28:31], s48 offen offset:3072 sc1
    s_waitcnt lgkmcnt(14)
    v_mfma_f32_32x32x16_bf16 v[144:159], v[164:167], v[236:239], v[144:159]
    ds_read_b64_tr_b16 v[164:165], v124 offset:12288
    ds_read_b64_tr_b16 v[166:167], v124 offset:13312
    v_add_f32 v52, 1.0, v52
    v_add_f32 v53, 1.0, v53
    v_add_f32 v54, 1.0, v54
    v_add_f32 v55, 1.0, v55
    s_add_u32 s48, s45, 4096
    buffer_load_dwordx4 v[232:235], v1, s[28:31], s48 offen offset:3072 sc1
    s_waitcnt lgkmcnt(14)
    v_mfma_f32_32x32x16_bf16 v[144:159], v[168:171], v[244:247], v[144:159]
    ds_read_b64_tr_b16 v[168:169], v124 offset:20480
    ds_read_b64_tr_b16 v[170:171], v124 offset:21504
    v_add_f32 v56, 1.0, v56
    v_add_f32 v57, 1.0, v57
    v_add_f32 v58, 1.0, v58
    v_add_f32 v59, 1.0, v59
    s_add_u32 s48, s45, 8192
    buffer_load_dwordx4 v[240:243], v1, s[28:31], s48 offen offset:3072 sc1
    s_waitcnt lgkmcnt(14)
    v_mfma_f32_32x32x16_bf16 v[144:159], v[172:175], v[252:255], v[144:159]
    ds_read_b64_tr_b16 v[172:173], v124 offset:28672
    ds_read_b64_tr_b16 v[174:175], v124 offset:29696
    v_add_f32 v60, 1.0, v60
    v_add_f32 v61, 1.0, v61
    v_add_f32 v62, 1.0, v62
    v_add_f32 v63, 1.0, v63
    s_add_u32 s48, s45, 12288
    buffer_load_dwordx4 v[248:251], v1, s[28:31], s48 offen offset:3072 sc1
    s_waitcnt lgkmcnt(14)
    v_mfma_f32_32x32x16_bf16 v[144:159], v[176:179], v[196:199], v[144:159]
    ds_read_b64_tr_b16 v[176:177], v124 offset:36864
    ds_read_b64_tr_b16 v[178:179], v124 offset:37888
    v_rcp_f32 v48, v48
    v_rcp_f32 v49, v49
    v_rcp_f32 v50, v50
    v_rcp_f32 v51, v51
    s_add_u32 s48, s45, 16384
    buffer_load_dwordx4 v[192:195], v1, s[28:31], s48 offen offset:3072 sc1
    s_waitcnt lgkmcnt(14)
    v_mfma_f32_32x32x16_bf16 v[144:159], v[180:183], v[204:207], v[144:159]
    ds_read_b64_tr_b16 v[180:181], v124 offset:45056
    ds_read_b64_tr_b16 v[182:183], v124 offset:46080
    v_rcp_f32 v52, v52
    v_rcp_f32 v53, v53
    v_rcp_f32 v54, v54
    v_rcp_f32 v55, v55
    s_add_u32 s48, s45, 20480
    buffer_load_dwordx4 v[200:203], v1, s[28:31], s48 offen offset:3072 sc1
    s_waitcnt lgkmcnt(14)
    v_mfma_f32_32x32x16_bf16 v[144:159], v[184:187], v[212:215], v[144:159]
    ds_read_b64_tr_b16 v[184:185], v124 offset:53248
    ds_read_b64_tr_b16 v[186:187], v124 offset:54272
    v_rcp_f32 v56, v56
    v_rcp_f32 v57, v57
    v_rcp_f32 v58, v58
    v_rcp_f32 v59, v59
    s_add_u32 s48, s45, 24576
    buffer_load_dwordx4 v[208:211], v1, s[28:31], s48 offen offset:3072 sc1
    s_waitcnt lgkmcnt(14)
    v_mfma_f32_32x32x16_bf16 v[144:159], v[188:191], v[220:223], v[144:159]
    ds_read_b64_tr_b16 v[188:189], v124 offset:61440
    ds_read_b64_tr_b16 v[190:191], v124 offset:62464
    v_rcp_f32 v60, v60
    v_rcp_f32 v61, v61
    v_rcp_f32 v62, v62
    v_rcp_f32 v63, v63
    s_add_u32 s48, s45, 28672
    buffer_load_dwordx4 v[216:219], v1, s[28:31], s48 offen offset:3072 sc1
    s_call_b64 s[60:61], kf_merge
    s_waitcnt vmcnt(8)
kf_b2:
    s_setprio 3
    v_max3_u32 v15, v16, v20, v24
    v_max3_u32 v15, v28, v32, v15
    v_max3_u32 v15, v36, v40, v15
    v_max_u32 v15, v44, v15
    v_cmp_eq_u32 vcc, -1, v15
    s_nop 0
    s_cbranch_vccz kf_b2x
    s_setprio 0
    s_cmp_lt_u32 s62, 7
    s_cbranch_scc1 1f
    s_sleep 12
1:
    s_add_u32 s48, s45, 0
    buffer_load_dwordx4 v[16:19], v1, s[28:31], s48 offen offset:2048 sc1
    s_add_u32 s48, s45, 4096
    buffer_load_dwordx4 v[20:23], v1, s[28:31], s48 offen offset:2048 sc1
    s_add_u32 s48, s45, 8192
    buffer_load_dwordx4 v[24:27], v1, s[28:31], s48 offen offset:2048 sc1
    s_add_u32 s48, s45, 12288
    buffer_load_dwordx4 v[28:31], v1, s[28:31], s48 offen offset:2048 sc1
    s_add_u32 s48, s45, 16384
    buffer_load_dwordx4 v[32:35], v1, s[28:31], s48 offen offset:2048 sc1
    s_add_u32 s48, s45, 20480
    buffer_load_dwordx4 v[36:39], v1, s[28:31], s48 offen offset:2048 sc1
    s_add_u32 s48, s45, 24576
    buffer_load_dwordx4 v[40:43], v1, s[28:31], s48 offen offset:2048 sc1
    s_add_u32 s48, s45, 28672
    buffer_load_dwordx4 v[44:47], v1, s[28:31], s48 offen offset:2048 sc1
    s_mov_b32 s41, 5
1:
    s_cmp_ge_u32 s62, 7
    s_cbranch_scc1 2f
    s_call_b64 s[60:61], kf_merge
    s_sleep 1
    s_sub_u32 s41, s41, 1
    s_cbranch_scc0 1b
2:
    s_waitcnt vmcnt(0)
    s_branch kf_b2
kf_b2x:
    s_waitcnt lgkmcnt(14)
    v_mfma_f32_32x32x16_bf16 v[144:159], v[160:163], v[16:19], v[144:159]
    ds_read_b64_tr_b16 v[160:161], v124 offset:6144
    ds_read_b64_tr_b16 v[162:163], v124 offset:7168
    v_pk_mul_f32 v[128:129], v[128:129], v[48:49]
    v_pk_mul_f32 v[130:131], v[130:131], v[50:51]
    v_pk_mul_f32 v[132:133], v[132:133], v[52:53]
    v_pk_mul_f32 v[134:135], v[134:135], v[54:55]
    s_waitcnt lgkmcnt(14)
    v_mfma_f32_32x32x16_bf16 v[144:159], v[164:167], v[20:23], v[144:159]
    ds_read_b64_tr_b16 v[164:165], v124 offset:14336
    ds_read_b64_tr_b16 v[166:167], v124 offset:15360
    v_pk_mul_f32 v[136:137], v[136:137], v[56:57]
    v_pk_mul_f32 v[138:139], v[138:139], v[58:59]
    v_pk_mul_f32 v[140:141], v[140:141], v[60:61]
    v_pk_mul_f32 v[142:143], v[142:143], v[62:63]
    s_waitcnt lgkmcnt(14)
    v_mfma_f32_32x32x16_bf16 v[144:159], v[168:171], v[24:27], v[144:159]
    ds_read_b64_tr_b16 v[168:169], v124 offset:22528
    ds_read_b64_tr_b16 v[170:171], v124 offset:23552
    v_permlane32_swap_b32 v112, v114
    v_permlane32_swap_b32 v113, v115
    v_permlane32_swap_b32 v116, v118
    v_permlane32_swap_b32 v117, v119
    s_waitcnt lgkmcnt(14)
    v_mfma_f32_32x32x16_bf16 v[144:159], v[172:175], v[28:31], v[144:159]
    ds_read_b64_tr_b16 v[172:173], v124 offset:30720
    ds_read_b64_tr_b16 v[174:175], v124 offset:31744
    v_lshlrev_b32 v48, 16, v112
    v_and_b32 v49, 0xffff0000, v112
    v_lshlrev_b32 v50, 16, v113
    v_and_b32 v51, 0xffff0000, v113
    s_waitcnt lgkmcnt(14)
    v_mfma_f32_32x32x16_bf16 v[144:159], v[176:179], v[32:35], v[144:159]
    ds_read_b64_tr_b16 v[176:177], v124 offset:38912
    ds_read_b64_tr_b16 v[178:179], v124 offset:39936
    v_lshlrev_b32 v52, 16, v114
    v_and_b32 v53, 0xffff0000, v114
    v_lshlrev_b32 v54, 16, v115
    v_and_b32 v55, 0xffff0000, v115
    s_waitcnt lgkmcnt(14)
    v_mfma_f32_32x32x16_bf16 v[144:159], v[180:183], v[36:39], v[144:159]
    ds_read_b64_tr_b16 v[180:181], v124 offset:47104
    ds_read_b64_tr_b16 v[182:183], v124 offset:48128
    v_lshlrev_b32 v56, 16, v116
    v_and_b32 v57, 0xffff0000, v116
    v_lshlrev_b32 v58, 16, v117
    v_and_b32 v59, 0xffff0000, v117
    s_waitcnt lgkmcnt(14)
    v_mfma_f32_32x32x16_bf16 v[144:159], v[184:187], v[40:43], v[144:159]
    ds_read_b64_tr_b16 v[184:185], v124 offset:55296
    ds_read_b64_tr_b16 v[186:187], v124 offset:56320
    v_lshlrev_b32 v60, 16, v118
    v_and_b32 v61, 0xffff0000, v118
    v_lshlrev_b32 v62, 16, v119
    v_and_b32 v63, 0xffff0000, v119
    s_waitcnt lgkmcnt(14)
    v_mfma_f32_32x32x16_bf16 v[144:159], v[188:191], v[44:47], v[144:159]
    ds_read_b64_tr_b16 v[188:189], v124 offset:63488
    ds_read_b64_tr_b16 v[190:191], v124 offset:64512
    s_mov_b32 s55, 0
    v_mov_b32 v8, 100408
    s_call_b64 s[60:61], kf_merge
    s_waitcnt vmcnt(0) lgkmcnt(0)
kf_b3:
    s_setprio 3
    v_cmp_eq_u32 s[4:5], -1, v224
    v_cmp_eq_u32 s[6:7], -1, v232
    v_cmp_eq_u32 s[8:9], -1, v240
    v_cmp_eq_u32 s[10:11], -1, v248
    v_cmp_eq_u32 s[64:65], -1, v192
    v_cmp_eq_u32 s[66:67], -1, v200
    v_cmp_eq_u32 s[68:69], -1, v208
    v_cmp_eq_u32 s[72:73], -1, v216
    s_bitcmp1_b32 s55, 0
    s_cbranch_scc1 1f
    s_cmp_lg_u64 s[4:5], 0
    s_cbranch_scc1 1f
    s_bitset1_b32 s55, 0
    v_mfma_f32_32x32x16_bf16 v[144:159], v[160:163], v[224:227], v[144:159]
1:
    s_bitcmp1_b32 s55, 1
    s_cbranch_scc1 1f
    s_cmp_lg_u64 s[6:7], 0
    s_cbranch_scc1 1f
    s_bitset1_b32 s55, 1
    v_mfma_f32_32x32x16_bf16 v[144:159], v[164:167], v[232:235], v[144:159]
1:
    s_bitcmp1_b32 s55, 2
    s_cbranch_scc1 1f
    s_cmp_lg_u64 s[8:9], 0
    s_cbranch_scc1 1f
    s_bitset1_b32 s55, 2
    v_mfma_f32_32x32x16_bf16 v[144:159], v[168:171], v[240:243], v[144:159]
1:
    s_bitcmp1_b32 s55, 3
    s_cbranch_scc1 1f
    s_cmp_lg_u64 s[10:11], 0
    s_cbranch_scc1 1f
    s_bitset1_b32 s55, 3
    v_mfma_f32_32x32x16_bf16 v[144:159], v[172:175], v[248:251], v[144:159]
1:
    s_bitcmp1_b32 s55, 4
    s_cbranch_scc1 1f
    s_cmp_lg_u64 s[64:65], 0
    s_cbranch_scc1 1f
    s_bitset1_b32 s55, 4
    v_mfma_f32_32x32x16_bf16 v[144:159], v[176:179], v[192:195], v[144:159]
1:
    s_bitcmp1_b32 s55, 5
    s_cbranch_scc1 1f
    s_cmp_lg_u64 s[66:67], 0
    s_cbranch_scc1 1f
    s_bitset1_b32 s55, 5
    v_mfma_f32_32x32x16_bf16 v[144:159], v[180:183], v[200:203], v[144:159]
1:
    s_bitcmp1_b32 s55, 6
    s_cbranch_scc1 1f
    s_cmp_lg_u64 s[68:69], 0
    s_cbranch_scc1 1f
    s_bitset1_b32 s55, 6
    v_mfma_f32_32x32x16_bf16 v[144:159], v[184:187], v[208:211], v[144:159]
1:
    s_bitcmp1_b32 s55, 7
    s_cbranch_scc1 1f
    s_cmp_lg_u64 s[72:73], 0
    s_cbranch_scc1 1f
    s_bitset1_b32 s55, 7
    v_mfma_f32_32x32x16_bf16 v[144:159], v[188:191], v[216:219], v[144:159]
1:
    s_cmp_eq_u32 s55, 0xff
    s_cbranch_scc1 kf_b3x
    s_setprio 0
    ds_read_b32 v9, v8
    s_call_b64 s[60:61], kf_merge
    s_waitcnt lgkmcnt(0)
    s_setprio 3
    v_readfirstlane_b32 s40, v9
    s_setprio 0
    s_cmp_ge_u32 s40, 1
    s_cbranch_scc1 2f
    s_sleep 6
2:
    s_bitcmp1_b32 s55, 0
    s_cbranch_scc1 1f
    s_add_u32 s48, s45, 0
    buffer_load_dwordx4 v[224:227], v1, s[28:31], s48 offen offset:3072 sc1
1:
    s_bitcmp1_b32 s55, 1
    s_cbranch_scc1 1f
    s_add_u32 s48, s45, 4096
    buffer_load_dwordx4 v[232:235], v1, s[28:31], s48 offen offset:3072 sc1
1:
    s_bitcmp1_b32 s55, 2
    s_cbranch_scc1 1f
    s_add_u32 s48, s45, 8192
    buffer_load_dwordx4 v[240:243], v1, s[28:31], s48 offen offset:3072 sc1
1:
    s_bitcmp1_b32 s55, 3
    s_cbranch_scc1 1f
    s_add_u32 s48, s45, 12288
    buffer_load_dwordx4 v[248:251], v1, s[28:31], s48 offen offset:3072 sc1
1:
    s_bitcmp1_b32 s55, 4
    s_cbranch_scc1 1f
    s_add_u32 s48, s45, 16384
    buffer_load_dwordx4 v[192:195], v1, s[28:31], s48 offen offset:3072 sc1
1:
    s_bitcmp1_b32 s55, 5
    s_cbranch_scc1 1f
    s_add_u32 s48, s45, 20480
    buffer_load_dwordx4 v[200:203], v1, s[28:31], s48 offen offset:3072 sc1
1:
    s_bitcmp1_b32 s55, 6
    s_cbranch_scc1 1f
    s_add_u32 s48, s45, 24576
    buffer_load_dwordx4 v[208:211], v1, s[28:31], s48 offen offset:3072 sc1
1:
    s_bitcmp1_b32 s55, 7
    s_cbranch_scc1 1f
    s_add_u32 s48, s45, 28672
    buffer_load_dwordx4 v[216:219], v1, s[28:31], s48 offen offset:3072 sc1
1:
    s_call_b64 s[60:61], kf_merge
    s_waitcnt vmcnt(0)
    s_branch kf_b3
kf_b3x:
    s_nop 9
    v_pk_fma_f32 v[144:145], v[144:145], v[128:129], v[48:49]
    v_pk_fma_f32 v[146:147], v[146:147], v[130:131], v[50:51]
    v_pk_fma_f32 v[148:149], v[148:149], v[132:133], v[52:53]
    v_pk_fma_f32 v[150:151], v[150:151], v[134:135], v[54:55]
    v_pk_fma_f32 v[152:153], v[152:153], v[136:137], v[56:57]
    v_pk_fma_f32 v[154:155], v[154:155], v[138:139], v[58:59]
    v_pk_fma_f32 v[156:157], v[156:157], v[140:141], v[60:61]
    v_pk_fma_f32 v[158:159], v[158:159], v[142:143], v[62:63]
    v_cvt_pk_bf16_f32 v112, v144, v145
    v_cvt_pk_bf16_f32 v113, v146, v147
    v_cvt_pk_bf16_f32 v114, v148, v149
    v_cvt_pk_bf16_f32 v115, v150, v151
    v_cvt_pk_bf16_f32 v116, v152, v153
    v_cvt_pk_bf16_f32 v117, v154, v155
    v_cvt_pk_bf16_f32 v118, v156, v157
    v_cvt_pk_bf16_f32 v119, v158, v159
    v_permlane32_swap_b32 v112, v114
    v_permlane32_swap_b32 v113, v115
    v_permlane32_swap_b32 v116, v118
    v_permlane32_swap_b32 v117, v119
    buffer_store_dwordx4 v[112:115], v7, s[20:23], s46 offen
    buffer_store_dwordx4 v[116:119], v7, s[20:23], s46 offen offset:32
kf_drain:
    s_call_b64 s[60:61], kf_merge
    s_cmp_ge_u32 s62, 7
    s_cbranch_scc1 kf_dend
    s_sleep 1
    s_branch kf_drain
kf_dend:
    s_endpgm
kf_merge:
    s_cmp_ge_u32 s62, 7
    s_cbranch_scc1 kf_mret
kf_merge7:
    ds_read_b128 v[68:71], v64
    s_waitcnt lgkmcnt(0)
    s_setprio 3
    v_or3_b32 v104, v68, v69, v70
    v_or_b32 v104, v104, v71
    v_cmp_gt_i32 vcc, 0, v104
    s_nop 0
    s_cbranch_vccnz kf_mret0
    ds_read_b32 v106, v67
    ds_read_b128 v[72:75], v65 offset:0
    ds_read_b128 v[76:79], v65 offset:1024
    ds_read_b128 v[80:83], v65 offset:2048
    ds_read_b128 v[84:87], v65 offset:3072
    ds_read_b128 v[88:91], v65 offset:4096
    ds_read_b128 v[92:95], v65 offset:5120
    ds_read_b128 v[96:99], v65 offset:6144
    ds_read_b128 v[100:103], v65 offset:7168
    ds_read_b32 v108, v66 offset:256
    s_waitcnt lgkmcnt(9)
    v_readfirstlane_b32 s58, v106
    s_nop 0
    s_cmp_lg_u32 s58, 0
    s_cbranch_scc1 kf_mslow
kf_mfast:
    v_add_f32 v104, v68, v69
    v_add_f32 v105, v70, v71
    v_add_f32 v104, v104, v105
    v_rcp_f32 v104, v104
    s_and_b32 s58, s62, 1
    s_lshl_b32 s58, s58, 15
    s_lshr_b32 s59, s62, 1
    s_lshl_b32 s59, s59, 10
    s_add_u32 s58, s58, s59
    s_add_u32 s58, s58, s63
    s_waitcnt lgkmcnt(5)
    v_pk_add_f32 v[72:73], v[72:73], v[80:81]
    v_pk_add_f32 v[74:75], v[74:75], v[82:83]
    v_pk_add_f32 v[76:77], v[76:77], v[84:85]
    v_pk_add_f32 v[78:79], v[78:79], v[86:87]
    s_waitcnt lgkmcnt(0)
    v_pk_add_f32 v[88:89], v[88:89], v[96:97]
    v_pk_add_f32 v[90:91], v[90:91], v[98:99]
    v_pk_add_f32 v[92:93], v[92:93], v[100:101]
    v_pk_add_f32 v[94:95], v[94:95], v[102:103]
    v_pk_add_f32 v[72:73], v[72:73], v[88:89]
    v_pk_add_f32 v[74:75], v[74:75], v[90:91]
    v_pk_add_f32 v[76:77], v[76:77], v[92:93]
    v_pk_add_f32 v[78:79], v[78:79], v[94:95]
    v_pk_mul_f32 v[72:73], v[72:73], v[104:105] op_sel_hi:[1,0]
    v_pk_mul_f32 v[74:75], v[74:75], v[104:105] op_sel_hi:[1,0]
    v_pk_mul_f32 v[76:77], v[76:77], v[104:105] op_sel_hi:[1,0]
    v_pk_mul_f32 v[78:79], v[78:79], v[104:105] op_sel_hi:[1,0]
    v_cvt_pk_bf16_f32 v80, v72, v73
    v_cvt_pk_bf16_f32 v81, v74, v75
    v_cvt_pk_bf16_f32 v82, v76, v77
    v_cvt_pk_bf16_f32 v83, v78, v79
    v_min_u32 v80, -2, v80
    buffer_store_dwordx4 v[80:83], v1, s[28:31], s58 offen sc1
    v_mov_b32 v109, v108
    v_mov_b32 v110, v108
    v_mov_b32 v111, v108
    s_cmp_ge_u32 s62, 6
    s_cbranch_scc1 1f
    ds_write_b128 v64, v[108:111] offset:4096
1:
    v_add_u32 v64, 2048, v64
    v_xor_b32 v65, 8192, v65
    v_add_u32 v66, 128, v66
    v_add_u32 v67, 4, v67
    s_add_u32 s62, s62, 1
kf_mret0:
    s_setprio 0
kf_mret:
    s_setpc_b64 s[60:61]
kf_mslow:
    ds_read_b32 v104, v66
    v_and_b32 v105, 127, v66
    s_and_b32 s59, s62, 1
    s_lshl_b32 s59, s59, 9
    s_add_u32 s59, s59, 99328
    v_add_u32 v105, s59, v105
    s_waitcnt lgkmcnt(0)
    v_lshlrev_b32 v104, 16, v104
    v_mov_b32 v106, v104
    v_mov_b32 v107, v104
    v_mov_b32 v109, v104
    v_mov_b32 v110, v104
    s_bitcmp1_b32 s58, 0
    s_cbranch_scc0 1f
    ds_read_b32 v106, v105 offset:0
1:
    s_bitcmp1_b32 s58, 1
    s_cbranch_scc0 1f
    ds_read_b32 v107, v105 offset:128
1:
    s_bitcmp1_b32 s58, 2
    s_cbranch_scc0 1f
    ds_read_b32 v109, v105 offset:256
1:
    s_bitcmp1_b32 s58, 3
    s_cbranch_scc0 1f
    ds_read_b32 v110, v105 offset:384
1:
    s_waitcnt lgkmcnt(0)
    v_min3_f32 v104, v106, v107, v109
    v_min_f32 v104, v104, v110
    v_sub_f32 v106, v104, v106
    v_exp_f32 v106, v106
    s_nop 0
    v_mul_f32 v68, v68, v106
    v_mul_f32 v72, v72, v106
    v_mul_f32 v73, v73, v106
    v_mul_f32 v74, v74, v106
    v_mul_f32 v75, v75, v106
    v_mul_f32 v76, v76, v106
    v_mul_f32 v77, v77, v106
    v_mul_f32 v78, v78, v106
    v_mul_f32 v79, v79, v106
    v_sub_f32 v107, v104, v107
    v_exp_f32 v107, v107
    s_nop 0
    v_mul_f32 v69, v69, v107
    v_mul_f32 v80, v80, v107
    v_mul_f32 v81, v81, v107
    v_mul_f32 v82, v82, v107
    v_mul_f32 v83, v83, v107
    v_mul_f32 v84, v84, v107
    v_mul_f32 v85, v85, v107
    v_mul_f32 v86, v86, v107
    v_mul_f32 v87, v87, v107
    v_sub_f32 v109, v104, v109
    v_exp_f32 v109, v109
    s_nop 0
    v_mul_f32 v70, v70, v109
    v_mul_f32 v88, v88, v109
    v_mul_f32 v89, v89, v109
    v_mul_f32 v90, v90, v109
    v_mul_f32 v91, v91, v109
    v_mul_f32 v92, v92, v109
    v_mul_f32 v93, v93, v109
    v_mul_f32 v94, v94, v109
    v_mul_f32 v95, v95, v109
    v_sub_f32 v110, v104, v110
    v_exp_f32 v110, v110
    s_nop 0
    v_mul_f32 v71, v71, v110
    v_mul_f32 v96, v96, v110
    v_mul_f32 v97, v97, v110
    v_mul_f32 v98, v98, v110
    v_mul_f32 v99, v99, v110
    v_mul_f32 v100, v100, v110
    v_mul_f32 v101, v101, v110
    v_mul_f32 v102, v102, v110
    v_mul_f32 v103, v103, v110
    s_branch kf_mfast
kf_pause:
    s_cmp_eq_u32 s55, 9
    s_cbranch_scc1 1f
    ds_read_b32 v8, v120
    ds_read_b128 v[12:15], v120 offset:32
    s_waitcnt lgkmcnt(0)
    s_setprio 3
    v_min3_u32 v12, v12, v13, v14
    v_min_u32 v12, v12, v15
    v_readfirstlane_b32 s40, v8
    v_readfirstlane_b32 s41, v12
    s_setprio 0
    s_cmp_lg_u32 s41, 0
    s_cbranch_scc1 kf_touch
    s_cmp_eq_u32 s55, 5
    s_cbranch_scc1 2f
    s_cmp_eq_u32 s40, 0
    s_cbranch_scc1 1f
2:
    s_sleep 2
    s_branch kf_pause
kf_touch:
    s_mov_b32 s55, 9
    s_cmp_ge_u32 s35, 3
    s_cbranch_scc1 1f
    s_setprio 3
    s_cmp_eq_u32 s35, 2
    s_cbranch_scc0 4f
    s_mov_b32 s24, s68
    s_and_b32 s25, s69, 0xffff
    s_mov_b32 s26, 1835008
    s_mov_b32 s27, 0x20000
    s_mov_b32 s96, s72
    s_and_b32 s97, s73, 0xffff
    s_mov_b32 s98, 524288
    s_mov_b32 s99, 0x20000
    v_min_u32 v8, 55, v2
    v_lshlrev_b32 v8, 7, v8
    s_mul_i32 s40, s2, 7168
    v_and_b32 v9, 15, v2
    v_lshlrev_b32 v9, 7, v9
    s_lshl_b32 s41, s2, 11
    s_setprio 0
    s_setpc_b64 s[60:61]
4:
    s_mov_b32 s24, s66
    s_and_b32 s25, s67, 0xffff
    s_mov_b32 s26, 1835008
    s_mov_b32 s27, 0x20000
    s_cmp_eq_u32 s35, 0
    s_cbranch_scc0 3f
    s_setprio 0
    s_setpc_b64 s[60:61]
3:
    s_setprio 0
1:
    s_setpc_b64 s[60:61]
kf_end:
    s_endpgm
.section .rodata,"a"
.p2align 6
.amdhsa_kernel recurrent_scan__grouped_kv_mqa__glu_gated_reglu__prompt_kernel
  .amdhsa_next_free_vgpr 256
  .amdhsa_next_free_sgpr 102
  .amdhsa_accum_offset 256
  .amdhsa_group_segment_fixed_size 0
  .amdhsa_kernarg_size 96
  .amdhsa_user_sgpr_count 2
  .amdhsa_user_sgpr_kernarg_segment_ptr 1
  .amdhsa_system_sgpr_workgroup_id_x 1
.end_amdhsa_kernel
```
